```python
import torch

def _softmax(x, axis=-1):
    return torch.softmax(x, dim=axis)
def _gelu(x):
    return torch.nn.functional.gelu(x, approximate="tanh")
def _silu(x):
    return torch.nn.functional.silu(x)
def _sigmoid(x):
    return torch.sigmoid(x)
def _layernorm(x, axis=-1, eps=1e-5):
    m = x.mean(dim=axis, keepdim=True)
    v = x.var(dim=axis, keepdim=True, unbiased=False)
    return (x - m) / torch.sqrt(v + eps)
def _scatter_add(tgt, idx, src, axis=0):
    return tgt.clone().index_add_(axis, idx, src)
def _segment_sum(src, seg, n):
    out = torch.zeros((n,) + src.shape[1:], dtype=src.dtype)
    return out.index_add_(0, seg, src)
def _pad(x, pw):
    flat = tuple(v for pair in reversed(pw) for v in pair)
    return torch.nn.functional.pad(x, flat)

kernel_name = 'standalone__cheap_equivariant_egnn__graph'

def setup_inputs():

    _w = (lambda a: (lambda t: t.to(torch.bfloat16) if t.is_floating_point() else t)(torch.as_tensor(a)))
    N, deg, D, De = 10000, 16, 256, max(4, 1)
    E = N * deg
    return {
        "h": _w((lambda *s: torch.randn(*s, dtype=torch.bfloat16) * 0.2)(N, D)),
        "pos": _w((lambda *s: torch.randn(*s, dtype=torch.bfloat16) * 0.4)(N, 3)),
        "e_attr": _w((lambda *s: torch.randn(*s, dtype=torch.bfloat16) * 0.4)(E, De)),
        "src": _w((lambda lo, hi, *s: torch.randint(lo, hi, s))(0, N, E).to(torch.int64)),
        "dst": _w((lambda lo, hi, *s: torch.randint(lo, hi, s))(0, N, E).to(torch.int64)),
        "w_e": _w(0.1 * (lambda *s: torch.randn(*s, dtype=torch.bfloat16) * 0.4)(2 * D + 1 + De, D)),
        "w_x": _w(0.1 * (lambda *s: torch.randn(*s, dtype=torch.bfloat16) * 0.2)(D, 1)),
        "w_h": _w(0.1 * (lambda *s: torch.randn(*s, dtype=torch.bfloat16) * 0.2)(2 * D, D)),
    }

def reference(h, pos, e_attr, src, dst, w_e, w_x, w_h):
    N, D = h.shape[0], h.shape[1]
    diff = pos[dst] - pos[src]
    dist2 = torch.sum(diff * diff, axis=-1, keepdims=True)
    e_in = torch.concatenate([h[dst], h[src], dist2, e_attr], axis=-1)
    m_ij = _silu(e_in @ w_e)
    coord_scale = m_ij @ w_x
    pos_new = pos + _segment_sum(diff * coord_scale, dst, N)
    m_i = _segment_sum(m_ij, dst, N)
    h_new = h + _silu(torch.concatenate([h, m_i], axis=-1) @ w_h)
    return h_new, pos_new
```

```asm
; @launch kernel=egnn_prep_kernel grid=(256,1,1) block=(512,1,1) lds=131072
; @launch kernel=egnn_main_kernel grid=(250,1,1) block=(256,1,1) lds=159040
.amdgcn_target "amdgcn-amd-amdhsa--gfx950"
.text
.globl egnn_prep_kernel
.p2align 8
.type egnn_prep_kernel,@function
egnn_prep_kernel:
  s_cmp_lt_u32 s2, 50
  s_cbranch_scc1 L_prep_sort
  s_cmp_lt_u32 s2, 56
  s_cbranch_scc1 L_prep_ref
  s_cmp_ge_u32 s2, 256
  s_cbranch_scc1 L_prep_exit
  s_load_dwordx16 s[4:19], s[0:1], 0
  s_load_dwordx2 s[20:21], s[0:1], 80
  v_and_b32 v1, 63, v0
  v_lshrrev_b32 v2, 6, v0
  s_nop 0
  v_readfirstlane_b32 s22, v2
  s_waitcnt lgkmcnt(0)
  s_sub_u32 s3, s2, 56
  s_lshr_b32 s48, s3, 4
  s_lshl_b32 s48, s48, 3
  s_and_b32 s49, s3, 7
  s_add_u32 s48, s48, s49
  s_bfe_u32 s49, s3, 0x10003
  s_sub_u32 s50, s3, 192
  s_and_b32 s51, s50, 3
  s_add_u32 s51, s51, 96
  s_lshr_b32 s50, s50, 2
  s_cmp_ge_u32 s3, 192
  s_cselect_b32 s48, s51, s48
  s_cselect_b32 s49, s50, s49
  s_mul_i32 s50, s48, 51200
  s_add_u32 s24, s14, 0x20000
  s_addc_u32 s25, s15, 0
  s_mov_b32 s26, 131072
  s_mov_b32 s27, 0x20000
  s_mov_b32 s28, s4
  s_mov_b32 s29, s5
  s_mov_b32 s30, 5120000
  s_mov_b32 s31, 0x20000
  s_add_u32 s51, s50, 4096
  s_add_u32 s32, s20, s51
  s_addc_u32 s33, s21, 0
  s_mov_b32 s34, 51200
  s_mov_b32 s35, 0x20000
  v_lshrrev_b32 v5, 5, v1
  s_lshl_b32 s46, s22, 1
  v_add_u32 v6, s46, v5
  v_and_b32 v7, 31, v1
  v_xor_b32 v6, v6, v7
  v_lshlrev_b32 v6, 4, v6
  v_lshl_add_u32 v6, v5, 9, v6
  s_lshl_b32 s46, s22, 10
  s_add_u32 s47, s50, s46
  s_add_u32 s46, s46, 65536
  s_add_u32 m0, s46, 0
  s_nop 0
  buffer_load_dwordx4 v6, s[28:31], s47 offen lds
  s_add_u32 m0, s46, 8192
  s_add_u32 s47, s47, 8192
  buffer_load_dwordx4 v6, s[28:31], s47 offen lds
  s_add_u32 m0, s46, 16384
  s_add_u32 s47, s47, 8192
  buffer_load_dwordx4 v6, s[28:31], s47 offen lds
  s_add_u32 m0, s46, 24576
  s_add_u32 s47, s47, 8192
  buffer_load_dwordx4 v6, s[28:31], s47 offen lds
  s_add_u32 m0, s46, 32768
  s_add_u32 s47, s47, 8192
  buffer_load_dwordx4 v6, s[28:31], s47 offen lds
  s_add_u32 m0, s46, 40960
  s_add_u32 s47, s47, 8192
  buffer_load_dwordx4 v6, s[28:31], s47 offen lds
  s_add_u32 m0, s46, 49152
  s_add_u32 s47, s47, 8192
  buffer_load_dwordx4 v6, s[28:31], s47 offen lds
  v_lshrrev_b32 v2, 4, v1
  v_bfe_u32 v3, v1, 1, 3
  v_xor_b32 v3, v3, v2
  v_lshlrev_b32 v3, 5, v3
  v_lshl_add_u32 v3, v2, 9, v3
  v_and_b32 v4, 1, v1
  v_lshl_add_u32 v3, v4, 4, v3
  v_xor_b32 v4, 0x80, v3
  s_lshl_b32 s44, s22, 14
  s_lshl_b32 s45, s49, 8
  s_add_u32 s44, s44, s45
  s_lshl_b32 s45, s22, 13
  s_add_u32 m0, s45, 0
  s_nop 0
  buffer_load_dwordx4 v3, s[24:27], s44 offen lds
  s_add_u32 m0, s45, 1024
  s_add_u32 s44, s44, 2048
  buffer_load_dwordx4 v3, s[24:27], s44 offen lds
  s_add_u32 m0, s45, 2048
  s_add_u32 s44, s44, 2048
  buffer_load_dwordx4 v4, s[24:27], s44 offen lds
  s_add_u32 m0, s45, 3072
  s_add_u32 s44, s44, 2048
  buffer_load_dwordx4 v4, s[24:27], s44 offen lds
  s_add_u32 m0, s45, 4096
  s_add_u32 s44, s44, 2048
  buffer_load_dwordx4 v3, s[24:27], s44 offen lds
  s_add_u32 m0, s45, 5120
  s_add_u32 s44, s44, 2048
  buffer_load_dwordx4 v3, s[24:27], s44 offen lds
  s_add_u32 m0, s45, 6144
  s_add_u32 s44, s44, 2048
  buffer_load_dwordx4 v4, s[24:27], s44 offen lds
  s_add_u32 m0, s45, 7168
  s_add_u32 s44, s44, 2048
  buffer_load_dwordx4 v4, s[24:27], s44 offen lds
  s_and_b32 s52, s22, 3
  s_lshr_b32 s53, s22, 2
  s_lshl_b32 s54, s52, 1
  v_lshrrev_b32 v10, 4, v1
  v_bfe_u32 v11, v1, 2, 2
  v_and_b32 v12, 1, v10
  v_lshl_or_b32 v12, v12, 2, v11
  s_add_u32 s46, s54, 0
  v_xor_b32 v12, s46, v12
  v_lshlrev_b32 v12, 5, v12
  v_lshl_add_u32 v13, v10, 3, v11
  v_lshl_add_u32 v12, v13, 8, v12
  v_and_b32 v13, 3, v1
  v_lshl_add_u32 v14, v13, 3, v12
  v_lshrrev_b32 v10, 4, v1
  v_bfe_u32 v11, v1, 2, 2
  v_and_b32 v12, 1, v10
  v_lshl_or_b32 v12, v12, 2, v11
  s_add_u32 s46, s54, 1
  v_xor_b32 v12, s46, v12
  v_lshlrev_b32 v12, 5, v12
  v_lshl_add_u32 v13, v10, 3, v11
  v_lshl_add_u32 v12, v13, 8, v12
  v_and_b32 v13, 3, v1
  v_lshl_add_u32 v15, v13, 3, v12
  v_and_b32 v10, 15, v1
  v_lshrrev_b32 v11, 4, v1
  v_xor_b32 v11, v11, v10
  s_lshl_b32 s46, s53, 15
  s_add_u32 s46, s46, 65536
  v_lshl_add_u32 v12, v10, 9, s46
  v_xor_b32 v13, 0, v11
  v_lshl_add_u32 v16, v13, 4, v12
  v_xor_b32 v13, 4, v11
  v_lshl_add_u32 v17, v13, 4, v12
  v_xor_b32 v13, 8, v11
  v_lshl_add_u32 v18, v13, 4, v12
  v_xor_b32 v13, 12, v11
  v_lshl_add_u32 v19, v13, 4, v12
  v_lshrrev_b32 v11, 4, v1
  v_and_b32 v13, 1, v11
  v_lshlrev_b32 v13, 5, v13
  v_lshrrev_b32 v11, 1, v11
  v_lshl_add_u32 v13, v11, 4, v13
  v_lshl_add_u32 v13, v10, 9, v13
  s_lshl_b32 s46, s49, 8
  s_lshl_b32 s47, s52, 6
  s_add_u32 s46, s46, s47
  v_add_u32 v20, s46, v13
  s_lshl_b32 s55, s53, 15
  s_waitcnt vmcnt(0)
  s_barrier
  ds_read_b64_tr_b16 v[56:57], v14 offset:0
  ds_read_b64_tr_b16 v[58:59], v14 offset:1024
  ds_read_b64_tr_b16 v[60:61], v15 offset:0
  ds_read_b64_tr_b16 v[62:63], v15 offset:1024
  ds_read_b128 v[64:67], v16 offset:0
  ds_read_b128 v[68:71], v16 offset:8192
  ds_read_b128 v[72:75], v16 offset:16384
  ds_read_b128 v[76:79], v16 offset:24576
  s_waitcnt lgkmcnt(0)
  ds_read_b64_tr_b16 v[80:81], v14 offset:8192
  ds_read_b64_tr_b16 v[82:83], v14 offset:9216
  ds_read_b64_tr_b16 v[84:85], v15 offset:8192
  ds_read_b64_tr_b16 v[86:87], v15 offset:9216
  ds_read_b128 v[88:91], v17 offset:0
  ds_read_b128 v[92:95], v17 offset:8192
  ds_read_b128 v[96:99], v17 offset:16384
  ds_read_b128 v[100:103], v17 offset:24576
  v_mfma_f32_16x16x32_bf16 v[24:27], v[56:59], v[64:67], 0
  v_mfma_f32_16x16x32_bf16 v[40:43], v[60:63], v[64:67], 0
  v_mfma_f32_16x16x32_bf16 v[28:31], v[56:59], v[68:71], 0
  v_mfma_f32_16x16x32_bf16 v[44:47], v[60:63], v[68:71], 0
  v_mfma_f32_16x16x32_bf16 v[32:35], v[56:59], v[72:75], 0
  v_mfma_f32_16x16x32_bf16 v[48:51], v[60:63], v[72:75], 0
  v_mfma_f32_16x16x32_bf16 v[36:39], v[56:59], v[76:79], 0
  v_mfma_f32_16x16x32_bf16 v[52:55], v[60:63], v[76:79], 0
  s_waitcnt lgkmcnt(0)
  ds_read_b64_tr_b16 v[56:57], v14 offset:16384
  ds_read_b64_tr_b16 v[58:59], v14 offset:17408
  ds_read_b64_tr_b16 v[60:61], v15 offset:16384
  ds_read_b64_tr_b16 v[62:63], v15 offset:17408
  ds_read_b128 v[64:67], v18 offset:0
  ds_read_b128 v[68:71], v18 offset:8192
  ds_read_b128 v[72:75], v18 offset:16384
  ds_read_b128 v[76:79], v18 offset:24576
  v_mfma_f32_16x16x32_bf16 v[24:27], v[80:83], v[88:91], v[24:27]
  v_mfma_f32_16x16x32_bf16 v[40:43], v[84:87], v[88:91], v[40:43]
  v_mfma_f32_16x16x32_bf16 v[28:31], v[80:83], v[92:95], v[28:31]
  v_mfma_f32_16x16x32_bf16 v[44:47], v[84:87], v[92:95], v[44:47]
  v_mfma_f32_16x16x32_bf16 v[32:35], v[80:83], v[96:99], v[32:35]
  v_mfma_f32_16x16x32_bf16 v[48:51], v[84:87], v[96:99], v[48:51]
  v_mfma_f32_16x16x32_bf16 v[36:39], v[80:83], v[100:103], v[36:39]
  v_mfma_f32_16x16x32_bf16 v[52:55], v[84:87], v[100:103], v[52:55]
  s_waitcnt lgkmcnt(0)
  ds_read_b64_tr_b16 v[80:81], v14 offset:24576
  ds_read_b64_tr_b16 v[82:83], v14 offset:25600
  ds_read_b64_tr_b16 v[84:85], v15 offset:24576
  ds_read_b64_tr_b16 v[86:87], v15 offset:25600
  ds_read_b128 v[88:91], v19 offset:0
  ds_read_b128 v[92:95], v19 offset:8192
  ds_read_b128 v[96:99], v19 offset:16384
  ds_read_b128 v[100:103], v19 offset:24576
  v_mfma_f32_16x16x32_bf16 v[24:27], v[56:59], v[64:67], v[24:27]
  v_mfma_f32_16x16x32_bf16 v[40:43], v[60:63], v[64:67], v[40:43]
  v_mfma_f32_16x16x32_bf16 v[28:31], v[56:59], v[68:71], v[28:31]
  v_mfma_f32_16x16x32_bf16 v[44:47], v[60:63], v[68:71], v[44:47]
  v_mfma_f32_16x16x32_bf16 v[32:35], v[56:59], v[72:75], v[32:35]
  v_mfma_f32_16x16x32_bf16 v[48:51], v[60:63], v[72:75], v[48:51]
  v_mfma_f32_16x16x32_bf16 v[36:39], v[56:59], v[76:79], v[36:39]
  v_mfma_f32_16x16x32_bf16 v[52:55], v[60:63], v[76:79], v[52:55]
  s_waitcnt lgkmcnt(0)
  ds_read_b64_tr_b16 v[56:57], v14 offset:32768
  ds_read_b64_tr_b16 v[58:59], v14 offset:33792
  ds_read_b64_tr_b16 v[60:61], v15 offset:32768
  ds_read_b64_tr_b16 v[62:63], v15 offset:33792
  ds_read_b128 v[64:67], v16 offset:256
  ds_read_b128 v[68:71], v16 offset:8448
  ds_read_b128 v[72:75], v16 offset:16640
  ds_read_b128 v[76:79], v16 offset:24832
  v_mfma_f32_16x16x32_bf16 v[24:27], v[80:83], v[88:91], v[24:27]
  v_mfma_f32_16x16x32_bf16 v[40:43], v[84:87], v[88:91], v[40:43]
  v_mfma_f32_16x16x32_bf16 v[28:31], v[80:83], v[92:95], v[28:31]
  v_mfma_f32_16x16x32_bf16 v[44:47], v[84:87], v[92:95], v[44:47]
  v_mfma_f32_16x16x32_bf16 v[32:35], v[80:83], v[96:99], v[32:35]
  v_mfma_f32_16x16x32_bf16 v[48:51], v[84:87], v[96:99], v[48:51]
  v_mfma_f32_16x16x32_bf16 v[36:39], v[80:83], v[100:103], v[36:39]
  v_mfma_f32_16x16x32_bf16 v[52:55], v[84:87], v[100:103], v[52:55]
  s_waitcnt lgkmcnt(0)
  ds_read_b64_tr_b16 v[80:81], v14 offset:40960
  ds_read_b64_tr_b16 v[82:83], v14 offset:41984
  ds_read_b64_tr_b16 v[84:85], v15 offset:40960
  ds_read_b64_tr_b16 v[86:87], v15 offset:41984
  ds_read_b128 v[88:91], v17 offset:256
  ds_read_b128 v[92:95], v17 offset:8448
  ds_read_b128 v[96:99], v17 offset:16640
  ds_read_b128 v[100:103], v17 offset:24832
  v_mfma_f32_16x16x32_bf16 v[24:27], v[56:59], v[64:67], v[24:27]
  v_mfma_f32_16x16x32_bf16 v[40:43], v[60:63], v[64:67], v[40:43]
  v_mfma_f32_16x16x32_bf16 v[28:31], v[56:59], v[68:71], v[28:31]
  v_mfma_f32_16x16x32_bf16 v[44:47], v[60:63], v[68:71], v[44:47]
  v_mfma_f32_16x16x32_bf16 v[32:35], v[56:59], v[72:75], v[32:35]
  v_mfma_f32_16x16x32_bf16 v[48:51], v[60:63], v[72:75], v[48:51]
  v_mfma_f32_16x16x32_bf16 v[36:39], v[56:59], v[76:79], v[36:39]
  v_mfma_f32_16x16x32_bf16 v[52:55], v[60:63], v[76:79], v[52:55]
  s_waitcnt lgkmcnt(0)
  ds_read_b64_tr_b16 v[56:57], v14 offset:49152
  ds_read_b64_tr_b16 v[58:59], v14 offset:50176
  ds_read_b64_tr_b16 v[60:61], v15 offset:49152
  ds_read_b64_tr_b16 v[62:63], v15 offset:50176
  ds_read_b128 v[64:67], v18 offset:256
  ds_read_b128 v[68:71], v18 offset:8448
  ds_read_b128 v[72:75], v18 offset:16640
  ds_read_b128 v[76:79], v18 offset:24832
  v_mfma_f32_16x16x32_bf16 v[24:27], v[80:83], v[88:91], v[24:27]
  v_mfma_f32_16x16x32_bf16 v[40:43], v[84:87], v[88:91], v[40:43]
  v_mfma_f32_16x16x32_bf16 v[28:31], v[80:83], v[92:95], v[28:31]
  v_mfma_f32_16x16x32_bf16 v[44:47], v[84:87], v[92:95], v[44:47]
  v_mfma_f32_16x16x32_bf16 v[32:35], v[80:83], v[96:99], v[32:35]
  v_mfma_f32_16x16x32_bf16 v[48:51], v[84:87], v[96:99], v[48:51]
  v_mfma_f32_16x16x32_bf16 v[36:39], v[80:83], v[100:103], v[36:39]
  v_mfma_f32_16x16x32_bf16 v[52:55], v[84:87], v[100:103], v[52:55]
  s_waitcnt lgkmcnt(0)
  ds_read_b64_tr_b16 v[80:81], v14 offset:57344
  ds_read_b64_tr_b16 v[82:83], v14 offset:58368
  ds_read_b64_tr_b16 v[84:85], v15 offset:57344
  ds_read_b64_tr_b16 v[86:87], v15 offset:58368
  ds_read_b128 v[88:91], v19 offset:256
  ds_read_b128 v[92:95], v19 offset:8448
  ds_read_b128 v[96:99], v19 offset:16640
  ds_read_b128 v[100:103], v19 offset:24832
  v_mfma_f32_16x16x32_bf16 v[24:27], v[56:59], v[64:67], v[24:27]
  v_mfma_f32_16x16x32_bf16 v[40:43], v[60:63], v[64:67], v[40:43]
  v_mfma_f32_16x16x32_bf16 v[28:31], v[56:59], v[68:71], v[28:31]
  v_mfma_f32_16x16x32_bf16 v[44:47], v[60:63], v[68:71], v[44:47]
  v_mfma_f32_16x16x32_bf16 v[32:35], v[56:59], v[72:75], v[32:35]
  v_mfma_f32_16x16x32_bf16 v[48:51], v[60:63], v[72:75], v[48:51]
  v_mfma_f32_16x16x32_bf16 v[36:39], v[56:59], v[76:79], v[36:39]
  v_mfma_f32_16x16x32_bf16 v[52:55], v[60:63], v[76:79], v[52:55]
  s_waitcnt lgkmcnt(0)
  v_mfma_f32_16x16x32_bf16 v[24:27], v[80:83], v[88:91], v[24:27]
  v_mfma_f32_16x16x32_bf16 v[40:43], v[84:87], v[88:91], v[40:43]
  v_mfma_f32_16x16x32_bf16 v[28:31], v[80:83], v[92:95], v[28:31]
  v_mfma_f32_16x16x32_bf16 v[44:47], v[84:87], v[92:95], v[44:47]
  v_mfma_f32_16x16x32_bf16 v[32:35], v[80:83], v[96:99], v[32:35]
  v_mfma_f32_16x16x32_bf16 v[48:51], v[84:87], v[96:99], v[48:51]
  v_mfma_f32_16x16x32_bf16 v[36:39], v[80:83], v[100:103], v[36:39]
  v_mfma_f32_16x16x32_bf16 v[52:55], v[84:87], v[100:103], v[52:55]
  s_mov_b32 s46, 0xbfb8aa3b
  s_mov_b32 s47, s46
  s_nop 7
  v_pk_mul_f32 v[24:25], v[24:25], s[46:47]
  v_pk_mul_f32 v[26:27], v[26:27], s[46:47]
  v_pk_mul_f32 v[40:41], v[40:41], s[46:47]
  v_pk_mul_f32 v[42:43], v[42:43], s[46:47]
  v_cvt_pk_bf16_f32 v56, v24, v25
  v_cvt_pk_bf16_f32 v57, v26, v27
  v_cvt_pk_bf16_f32 v58, v40, v41
  v_cvt_pk_bf16_f32 v59, v42, v43
  s_nop 1
  v_permlane16_swap_b32 v56, v58
  v_permlane16_swap_b32 v57, v59
  buffer_store_dwordx4 v[56:59], v20, s[32:35], s55 offen sc1
  s_add_u32 s55, s55, 8192
  v_pk_mul_f32 v[28:29], v[28:29], s[46:47]
  v_pk_mul_f32 v[30:31], v[30:31], s[46:47]
  v_pk_mul_f32 v[44:45], v[44:45], s[46:47]
  v_pk_mul_f32 v[46:47], v[46:47], s[46:47]
  v_cvt_pk_bf16_f32 v60, v28, v29
  v_cvt_pk_bf16_f32 v61, v30, v31
  v_cvt_pk_bf16_f32 v62, v44, v45
  v_cvt_pk_bf16_f32 v63, v46, v47
  s_nop 1
  v_permlane16_swap_b32 v60, v62
  v_permlane16_swap_b32 v61, v63
  buffer_store_dwordx4 v[60:63], v20, s[32:35], s55 offen sc1
  s_add_u32 s55, s55, 8192
  v_pk_mul_f32 v[32:33], v[32:33], s[46:47]
  v_pk_mul_f32 v[34:35], v[34:35], s[46:47]
  v_pk_mul_f32 v[48:49], v[48:49], s[46:47]
  v_pk_mul_f32 v[50:51], v[50:51], s[46:47]
  v_cvt_pk_bf16_f32 v64, v32, v33
  v_cvt_pk_bf16_f32 v65, v34, v35
  v_cvt_pk_bf16_f32 v66, v48, v49
  v_cvt_pk_bf16_f32 v67, v50, v51
  s_nop 1
  v_permlane16_swap_b32 v64, v66
  v_permlane16_swap_b32 v65, v67
  buffer_store_dwordx4 v[64:67], v20, s[32:35], s55 offen sc1
  s_add_u32 s55, s55, 8192
  v_pk_mul_f32 v[36:37], v[36:37], s[46:47]
  v_pk_mul_f32 v[38:39], v[38:39], s[46:47]
  v_pk_mul_f32 v[52:53], v[52:53], s[46:47]
  v_pk_mul_f32 v[54:55], v[54:55], s[46:47]
  v_cvt_pk_bf16_f32 v68, v36, v37
  v_cvt_pk_bf16_f32 v69, v38, v39
  v_cvt_pk_bf16_f32 v70, v52, v53
  v_cvt_pk_bf16_f32 v71, v54, v55
  s_nop 1
  v_permlane16_swap_b32 v68, v70
  v_permlane16_swap_b32 v69, v71
  buffer_store_dwordx4 v[68:71], v20, s[32:35], s55 offen sc1
  s_endpgm
L_prep_sort:
  s_load_dwordx16 s[4:19], s[0:1], 0
  s_load_dwordx2 s[20:21], s[0:1], 80
  v_and_b32 v1, 63, v0
  v_lshrrev_b32 v2, 6, v0
  s_nop 0
  v_readfirstlane_b32 s22, v2
  s_waitcnt lgkmcnt(0)
  s_mul_i32 s48, s2, 12800
  s_mul_i32 s49, s2, 25600
  s_add_u32 s24, s12, s48
  s_addc_u32 s25, s13, 0
  s_mov_b32 s26, 12800
  s_mov_b32 s27, 0x20000
  s_add_u32 s28, s10, s48
  s_addc_u32 s29, s11, 0
  s_mov_b32 s30, 12800
  s_mov_b32 s31, 0x20000
  s_add_u32 s32, s8, s49
  s_addc_u32 s33, s9, 0
  s_mov_b32 s34, 25600
  s_mov_b32 s35, 0x20000
  v_lshlrev_b32 v2, 2, v0
  v_lshlrev_b32 v3, 3, v0
  s_movk_i32 s46, 0
  s_movk_i32 s47, 0
  buffer_load_dword v8, v2, s[24:27], s46 offen
  buffer_load_dword v16, v2, s[28:31], s46 offen
  buffer_load_dwordx2 v[24:25], v3, s[32:35], s47 offen
  s_movk_i32 s46, 2048
  s_movk_i32 s47, 4096
  buffer_load_dword v9, v2, s[24:27], s46 offen
  buffer_load_dword v17, v2, s[28:31], s46 offen
  buffer_load_dwordx2 v[26:27], v3, s[32:35], s47 offen
  s_movk_i32 s46, 4096
  s_movk_i32 s47, 8192
  buffer_load_dword v10, v2, s[24:27], s46 offen
  buffer_load_dword v18, v2, s[28:31], s46 offen
  buffer_load_dwordx2 v[28:29], v3, s[32:35], s47 offen
  s_movk_i32 s46, 6144
  s_movk_i32 s47, 12288
  buffer_load_dword v11, v2, s[24:27], s46 offen
  buffer_load_dword v19, v2, s[28:31], s46 offen
  buffer_load_dwordx2 v[30:31], v3, s[32:35], s47 offen
  s_movk_i32 s46, 8192
  s_movk_i32 s47, 16384
  buffer_load_dword v12, v2, s[24:27], s46 offen
  buffer_load_dword v20, v2, s[28:31], s46 offen
  buffer_load_dwordx2 v[32:33], v3, s[32:35], s47 offen
  s_movk_i32 s46, 10240
  s_movk_i32 s47, 20480
  buffer_load_dword v13, v2, s[24:27], s46 offen
  buffer_load_dword v21, v2, s[28:31], s46 offen
  buffer_load_dwordx2 v[34:35], v3, s[32:35], s47 offen
  s_movk_i32 s46, 12288
  s_movk_i32 s47, 24576
  buffer_load_dword v14, v2, s[24:27], s46 offen
  buffer_load_dword v22, v2, s[28:31], s46 offen
  buffer_load_dwordx2 v[36:37], v3, s[32:35], s47 offen
  s_mul_i32 s50, s2, 1200
  s_mul_i32 s51, s2, 1600
  s_add_u32 s51, s51, 7471104
  s_add_u32 s36, s6, s50
  s_addc_u32 s37, s7, 0
  s_mov_b32 s38, 1200
  s_mov_b32 s39, 0x20000
  s_add_u32 s40, s20, s51
  s_addc_u32 s41, s21, 0
  s_mov_b32 s42, 1600
  s_mov_b32 s43, 0x20000
  v_mul_u32_u24 v4, 6, v0
  buffer_load_ushort v40, v4, s[36:39], 0 offen offset:0
  buffer_load_ushort v41, v4, s[36:39], 0 offen offset:2
  buffer_load_ushort v42, v4, s[36:39], 0 offen offset:4
  v_mov_b32 v5, 0
  v_cmp_gt_u32 vcc, 256, v0
  s_and_saveexec_b64 s[52:53], vcc
  s_cbranch_execz L_sort_zero_done
  ds_write_b32 v2, v5 offset:0
L_sort_zero_done:
  s_mov_b64 exec, s[52:53]
  s_waitcnt lgkmcnt(0)
  s_barrier
  s_waitcnt vmcnt(21)
  s_mov_b32 s46, 52429
  v_mov_b32 v6, 1
  v_mul_u32_u24 v5, s46, v8
  v_lshrrev_b32 v5, 21, v5
  v_mul_u32_u24 v7, 40, v5
  v_sub_u32 v7, v8, v7
  v_lshl_add_u32 v16, v16, 9, v7
  v_lshlrev_b32 v44, 2, v5
  ds_add_rtn_u32 v52, v44, v6 offset:0
  s_waitcnt vmcnt(18)
  v_mul_u32_u24 v5, s46, v9
  v_lshrrev_b32 v5, 21, v5
  v_mul_u32_u24 v7, 40, v5
  v_sub_u32 v7, v9, v7
  v_lshl_add_u32 v17, v17, 9, v7
  v_lshlrev_b32 v45, 2, v5
  ds_add_rtn_u32 v53, v45, v6 offset:0
  s_waitcnt vmcnt(15)
  v_mul_u32_u24 v5, s46, v10
  v_lshrrev_b32 v5, 21, v5
  v_mul_u32_u24 v7, 40, v5
  v_sub_u32 v7, v10, v7
  v_lshl_add_u32 v18, v18, 9, v7
  v_lshlrev_b32 v46, 2, v5
  ds_add_rtn_u32 v54, v46, v6 offset:0
  s_waitcnt vmcnt(12)
  v_mul_u32_u24 v5, s46, v11
  v_lshrrev_b32 v5, 21, v5
  v_mul_u32_u24 v7, 40, v5
  v_sub_u32 v7, v11, v7
  v_lshl_add_u32 v19, v19, 9, v7
  v_lshlrev_b32 v47, 2, v5
  ds_add_rtn_u32 v55, v47, v6 offset:0
  s_waitcnt vmcnt(9)
  v_mul_u32_u24 v5, s46, v12
  v_lshrrev_b32 v5, 21, v5
  v_mul_u32_u24 v7, 40, v5
  v_sub_u32 v7, v12, v7
  v_lshl_add_u32 v20, v20, 9, v7
  v_lshlrev_b32 v48, 2, v5
  ds_add_rtn_u32 v56, v48, v6 offset:0
  s_waitcnt vmcnt(6)
  v_mul_u32_u24 v5, s46, v13
  v_lshrrev_b32 v5, 21, v5
  v_mul_u32_u24 v7, 40, v5
  v_sub_u32 v7, v13, v7
  v_lshl_add_u32 v21, v21, 9, v7
  v_lshlrev_b32 v49, 2, v5
  ds_add_rtn_u32 v57, v49, v6 offset:0
  s_cmp_ge_u32 s22, 2
  s_cbranch_scc1 L_sort_r6a
  s_waitcnt vmcnt(3)
  v_mul_u32_u24 v5, s46, v14
  v_lshrrev_b32 v5, 21, v5
  v_mul_u32_u24 v7, 40, v5
  v_sub_u32 v7, v14, v7
  v_lshl_add_u32 v22, v22, 9, v7
  v_lshlrev_b32 v50, 2, v5
  ds_add_rtn_u32 v58, v50, v6 offset:0
L_sort_r6a:
  s_waitcnt vmcnt(0)
  v_lshl_or_b32 v40, v41, 16, v40
  v_mov_b32 v41, v42
  buffer_store_dwordx2 v[40:41], v3, s[40:43], 0 offen sc1
  s_waitcnt lgkmcnt(0)
  s_barrier
  s_cmp_lg_u32 s22, 0
  s_cbranch_scc1 L_sort_scan_done
  v_lshlrev_b32 v4, 4, v1
  ds_read_b128 v[60:63], v4 offset:0
  s_waitcnt lgkmcnt(0)
  v_add_u32 v65, v60, v61
  v_add_u32 v66, v65, v62
  v_add_u32 v67, v66, v63
  v_mov_b32 v68, v67
  s_nop 1
  v_add_u32_dpp v68, v68, v68 row_shr:1 row_mask:0xf bank_mask:0xf bound_ctrl:0
  s_nop 1
  v_add_u32_dpp v68, v68, v68 row_shr:2 row_mask:0xf bank_mask:0xf bound_ctrl:0
  s_nop 1
  v_add_u32_dpp v68, v68, v68 row_shr:4 row_mask:0xf bank_mask:0xf bound_ctrl:0
  s_nop 1
  v_add_u32_dpp v68, v68, v68 row_shr:8 row_mask:0xf bank_mask:0xf bound_ctrl:0
  s_nop 1
  v_add_u32_dpp v68, v68, v68 row_bcast:15 row_mask:0xa bank_mask:0xf
  s_nop 1
  v_add_u32_dpp v68, v68, v68 row_bcast:31 row_mask:0xc bank_mask:0xf
  v_sub_u32 v72, v68, v67
  v_add_u32 v73, v72, v60
  v_add_u32 v74, v72, v65
  v_add_u32 v75, v72, v66
  ds_write_b128 v4, v[72:75] offset:1024
  s_lshl_b32 s50, s2, 2
  s_add_u32 s50, s50, 7340032
  s_add_u32 s36, s20, s50
  s_addc_u32 s37, s21, 0
  s_mov_b32 s38, 63800
  s_mov_b32 s39, 0x20000
  v_lshlrev_b32 v5, 10, v1
  v_lshl_or_b32 v76, v60, 16, v72
  buffer_store_dword v76, v5, s[36:39], 0 offen offset:0 sc1
  v_lshl_or_b32 v77, v61, 16, v73
  buffer_store_dword v77, v5, s[36:39], 0 offen offset:256 sc1
  v_lshl_or_b32 v78, v62, 16, v74
  buffer_store_dword v78, v5, s[36:39], 0 offen offset:512 sc1
  v_lshl_or_b32 v79, v63, 16, v75
  buffer_store_dword v79, v5, s[36:39], 0 offen offset:768 sc1
  s_waitcnt lgkmcnt(0)
L_sort_scan_done:
  s_barrier
  ds_read_b32 v60, v44 offset:1024
  ds_read_b32 v61, v45 offset:1024
  ds_read_b32 v62, v46 offset:1024
  ds_read_b32 v63, v47 offset:1024
  ds_read_b32 v64, v48 offset:1024
  ds_read_b32 v65, v49 offset:1024
  s_cmp_ge_u32 s22, 2
  s_cbranch_scc1 L_sort_r6b
  ds_read_b32 v66, v50 offset:1024
L_sort_r6b:
  s_waitcnt lgkmcnt(0)
  v_add_u32 v5, v60, v52
  v_lshlrev_b32 v7, 3, v5
  v_lshlrev_b32 v5, 2, v5
  ds_write_b32 v5, v16 offset:2048
  ds_write_b64 v7, v[24:25] offset:16384
  v_add_u32 v5, v61, v53
  v_lshlrev_b32 v7, 3, v5
  v_lshlrev_b32 v5, 2, v5
  ds_write_b32 v5, v17 offset:2048
  ds_write_b64 v7, v[26:27] offset:16384
  v_add_u32 v5, v62, v54
  v_lshlrev_b32 v7, 3, v5
  v_lshlrev_b32 v5, 2, v5
  ds_write_b32 v5, v18 offset:2048
  ds_write_b64 v7, v[28:29] offset:16384
  v_add_u32 v5, v63, v55
  v_lshlrev_b32 v7, 3, v5
  v_lshlrev_b32 v5, 2, v5
  ds_write_b32 v5, v19 offset:2048
  ds_write_b64 v7, v[30:31] offset:16384
  v_add_u32 v5, v64, v56
  v_lshlrev_b32 v7, 3, v5
  v_lshlrev_b32 v5, 2, v5
  ds_write_b32 v5, v20 offset:2048
  ds_write_b64 v7, v[32:33] offset:16384
  v_add_u32 v5, v65, v57
  v_lshlrev_b32 v7, 3, v5
  v_lshlrev_b32 v5, 2, v5
  ds_write_b32 v5, v21 offset:2048
  ds_write_b64 v7, v[34:35] offset:16384
  s_cmp_ge_u32 s22, 2
  s_cbranch_scc1 L_sort_r6c
  v_add_u32 v5, v66, v58
  v_lshlrev_b32 v7, 3, v5
  v_lshlrev_b32 v5, 2, v5
  ds_write_b32 v5, v22 offset:2048
  ds_write_b64 v7, v[36:37] offset:16384
L_sort_r6c:
  s_waitcnt lgkmcnt(0)
  s_barrier
  s_add_u32 s50, s48, 5242880
  s_add_u32 s51, s49, 5898240
  s_add_u32 s24, s20, s50
  s_addc_u32 s25, s21, 0
  s_mov_b32 s26, 12800
  s_mov_b32 s27, 0x20000
  s_add_u32 s28, s20, s51
  s_addc_u32 s29, s21, 0
  s_mov_b32 s30, 25600
  s_mov_b32 s31, 0x20000
  v_lshlrev_b32 v4, 4, v0
  ds_read_b128 v[80:83], v4 offset:2048
  ds_read_b128 v[84:87], v4 offset:10240
  ds_read_b128 v[88:91], v4 offset:16384
  ds_read_b128 v[92:95], v4 offset:24576
  ds_read_b128 v[96:99], v4 offset:32768
  ds_read_b128 v[100:103], v4 offset:40960
  s_movk_i32 s46, 0
  s_waitcnt lgkmcnt(5)
  buffer_store_dwordx4 v[80:83], v4, s[24:27], s46 offen sc1
  s_movk_i32 s46, 8192
  s_waitcnt lgkmcnt(4)
  buffer_store_dwordx4 v[84:87], v4, s[24:27], s46 offen sc1
  s_movk_i32 s46, 0
  s_waitcnt lgkmcnt(3)
  buffer_store_dwordx4 v[88:91], v4, s[28:31], s46 offen sc1
  s_movk_i32 s46, 8192
  s_waitcnt lgkmcnt(2)
  buffer_store_dwordx4 v[92:95], v4, s[28:31], s46 offen sc1
  s_movk_i32 s46, 16384
  s_waitcnt lgkmcnt(1)
  buffer_store_dwordx4 v[96:99], v4, s[28:31], s46 offen sc1
  s_movk_i32 s46, 24576
  s_waitcnt lgkmcnt(0)
  buffer_store_dwordx4 v[100:103], v4, s[28:31], s46 offen sc1
  s_endpgm
L_prep_ref:
  s_load_dwordx16 s[4:19], s[0:1], 0
  s_load_dwordx2 s[20:21], s[0:1], 80
  v_and_b32 v1, 63, v0
  v_lshrrev_b32 v2, 6, v0
  s_nop 0
  v_readfirstlane_b32 s22, v2
  s_waitcnt lgkmcnt(0)
  s_sub_u32 s3, s2, 50
  s_lshr_b32 s48, s3, 1
  s_and_b32 s49, s3, 1
  s_cmp_eq_u32 s48, 0
  s_cselect_b32 s50, s14, s18
  s_cselect_b32 s51, s15, s19
  s_cmp_eq_u32 s48, 2
  s_cselect_b32 s52, 131072, 0
  s_add_u32 s24, s50, s52
  s_addc_u32 s25, s51, 0
  s_mov_b32 s26, 131072
  s_mov_b32 s27, 0x20000
  v_lshrrev_b32 v2, 4, v1
  v_bfe_u32 v3, v1, 1, 3
  v_xor_b32 v3, v3, v2
  v_lshlrev_b32 v3, 5, v3
  v_lshl_add_u32 v3, v2, 9, v3
  v_and_b32 v4, 1, v1
  v_lshl_add_u32 v3, v4, 4, v3
  v_xor_b32 v4, 0x80, v3
  s_lshl_b32 s44, s22, 14
  s_lshl_b32 s45, s49, 8
  s_add_u32 s44, s44, s45
  s_lshl_b32 s45, s22, 13
  s_add_u32 m0, s45, 0
  s_nop 0
  buffer_load_dwordx4 v3, s[24:27], s44 offen lds
  s_add_u32 m0, s45, 1024
  s_add_u32 s44, s44, 2048
  buffer_load_dwordx4 v3, s[24:27], s44 offen lds
  s_add_u32 m0, s45, 2048
  s_add_u32 s44, s44, 2048
  buffer_load_dwordx4 v4, s[24:27], s44 offen lds
  s_add_u32 m0, s45, 3072
  s_add_u32 s44, s44, 2048
  buffer_load_dwordx4 v4, s[24:27], s44 offen lds
  s_add_u32 m0, s45, 4096
  s_add_u32 s44, s44, 2048
  buffer_load_dwordx4 v3, s[24:27], s44 offen lds
  s_add_u32 m0, s45, 5120
  s_add_u32 s44, s44, 2048
  buffer_load_dwordx4 v3, s[24:27], s44 offen lds
  s_add_u32 m0, s45, 6144
  s_add_u32 s44, s44, 2048
  buffer_load_dwordx4 v4, s[24:27], s44 offen lds
  s_add_u32 m0, s45, 7168
  s_add_u32 s44, s44, 2048
  buffer_load_dwordx4 v4, s[24:27], s44 offen lds
  s_lshl_b32 s52, s48, 17
  s_add_u32 s52, s52, 7602176
  s_add_u32 s28, s20, s52
  s_addc_u32 s29, s21, 0
  s_mov_b32 s30, 131072
  s_mov_b32 s31, 0x20000
  s_cmp_lg_u32 s48, 0
  s_cbranch_scc1 L_ref_nowx
  s_cmp_ge_u32 s22, 4
  s_cbranch_scc1 L_ref_nowx
  s_add_u32 s32, s14, 0x40000
  s_addc_u32 s33, s15, 0
  s_mov_b32 s34, 2560
  s_mov_b32 s35, 0x20000
  s_add_u32 s36, s20, 0x7a0000
  s_addc_u32 s37, s21, 0
  s_mov_b32 s38, 4096
  s_mov_b32 s39, 0x20000
  s_lshl_b32 s46, s49, 2
  s_add_u32 s46, s46, s22
  v_and_b32 v20, 31, v1
  s_lshl_b32 s47, s46, 6
  v_lshl_add_u32 v20, v20, 1, s47
  buffer_load_ushort v22, v20, s[32:35], 0 offen offset:0
  buffer_load_ushort v23, v20, s[32:35], 0 offen offset:512
  buffer_load_ushort v24, v20, s[32:35], 0 offen offset:1024
  buffer_load_ushort v25, v20, s[32:35], 0 offen offset:1536
  buffer_load_ushort v26, v20, s[32:35], 0 offen offset:2048
  s_waitcnt vmcnt(0)
  s_mov_b32 s47, 0xbfb8aa3b
  v_lshlrev_b32 v22, 16, v22
  v_mul_f32 v22, s47, v22
  v_cvt_pk_bf16_f32 v28, v22, v22
  v_and_b32 v27, 0xffff0000, v28
  v_sub_f32 v27, v22, v27
  v_cvt_pk_bf16_f32 v34, v27, v27
  v_lshlrev_b32 v23, 16, v23
  v_mul_f32 v23, s47, v23
  v_cvt_pk_bf16_f32 v29, v23, v23
  v_and_b32 v27, 0xffff0000, v29
  v_sub_f32 v27, v23, v27
  v_cvt_pk_bf16_f32 v35, v27, v27
  v_lshlrev_b32 v24, 16, v24
  v_mul_f32 v24, s47, v24
  v_cvt_pk_bf16_f32 v30, v24, v24
  v_and_b32 v27, 0xffff0000, v30
  v_sub_f32 v27, v24, v27
  v_cvt_pk_bf16_f32 v36, v27, v27
  v_lshlrev_b32 v25, 16, v25
  v_mul_f32 v25, s47, v25
  v_cvt_pk_bf16_f32 v31, v25, v25
  v_and_b32 v27, 0xffff0000, v31
  v_sub_f32 v27, v25, v27
  v_cvt_pk_bf16_f32 v37, v27, v27
  v_lshlrev_b32 v26, 16, v26
  v_mul_f32 v26, s47, v26
  v_cvt_pk_bf16_f32 v32, v26, v26
  v_and_b32 v27, 0xffff0000, v32
  v_sub_f32 v27, v26, v27
  v_cvt_pk_bf16_f32 v38, v27, v27
  s_mov_b32 s47, 0xffff
  v_and_b32 v40, s47, v29
  v_lshl_or_b32 v40, v30, 16, v40
  v_and_b32 v41, s47, v31
  v_lshl_or_b32 v41, v32, 16, v41
  v_and_b32 v42, s47, v28
  v_lshl_or_b32 v42, v34, 16, v42
  v_and_b32 v43, s47, v35
  v_lshl_or_b32 v43, v36, 16, v43
  v_cmp_gt_u32 vcc, 32, v1
  s_nop 1
  v_cndmask_b32 v44, v42, v40, vcc
  v_cndmask_b32 v45, v43, v41, vcc
  v_lshlrev_b32 v20, 3, v1
  s_lshl_b32 s46, s46, 9
  buffer_store_dwordx2 v[44:45], v20, s[36:39], s46 offen sc1
L_ref_nowx:
  s_waitcnt vmcnt(0)
  s_barrier
  v_lshlrev_b32 v21, 4, v1
  s_cmp_lg_u32 s48, 0
  s_cbranch_scc1 L_ref_k16
  s_lshr_b32 s52, s22, 2
  s_bfe_u32 s53, s22, 0x10001
  s_and_b32 s54, s22, 1
  s_lshl_b32 s55, s52, 2
  s_lshl_b32 s56, s53, 1
  s_add_u32 s55, s55, s56
  v_lshrrev_b32 v10, 5, v1
  v_bfe_u32 v11, v1, 4, 1
  v_bfe_u32 v12, v1, 2, 2
  v_lshl_or_b32 v13, v10, 2, v12
  v_add_u32 v11, s55, v11
  v_xor_b32 v11, v11, v13
  v_lshlrev_b32 v11, 5, v11
  v_lshl_add_u32 v13, v10, 3, v12
  v_lshl_add_u32 v11, v13, 8, v11
  v_and_b32 v13, 3, v1
  v_lshl_add_u32 v11, v13, 3, v11
  s_lshl_b32 s56, s54, 15
  v_add_u32 v11, s56, v11
  s_lshl_b32 s56, s49, 1
  s_add_u32 s56, s56, s52
  s_lshl_b32 s56, s56, 4
  s_lshl_b32 s57, s54, 3
  s_add_u32 s56, s56, s57
  s_lshl_b32 s56, s56, 1
  s_add_u32 s56, s56, s53
  s_lshl_b32 s56, s56, 10
  ds_read_b64_tr_b16 v[24:25], v11 offset:0
  ds_read_b64_tr_b16 v[26:27], v11 offset:1024
  ds_read_b64_tr_b16 v[28:29], v11 offset:4096
  ds_read_b64_tr_b16 v[30:31], v11 offset:5120
  ds_read_b64_tr_b16 v[32:33], v11 offset:8192
  ds_read_b64_tr_b16 v[34:35], v11 offset:9216
  ds_read_b64_tr_b16 v[36:37], v11 offset:12288
  ds_read_b64_tr_b16 v[38:39], v11 offset:13312
  ds_read_b64_tr_b16 v[40:41], v11 offset:16384
  ds_read_b64_tr_b16 v[42:43], v11 offset:17408
  ds_read_b64_tr_b16 v[44:45], v11 offset:20480
  ds_read_b64_tr_b16 v[46:47], v11 offset:21504
  ds_read_b64_tr_b16 v[48:49], v11 offset:24576
  ds_read_b64_tr_b16 v[50:51], v11 offset:25600
  s_waitcnt lgkmcnt(12)
  ds_read_b64_tr_b16 v[52:53], v11 offset:28672
  ds_read_b64_tr_b16 v[54:55], v11 offset:29696
  buffer_store_dwordx4 v[24:27], v21, s[28:31], s56 offen sc1
  s_add_u32 s56, s56, 2048
  s_waitcnt lgkmcnt(12)
  buffer_store_dwordx4 v[28:31], v21, s[28:31], s56 offen sc1
  s_add_u32 s56, s56, 2048
  s_waitcnt lgkmcnt(10)
  buffer_store_dwordx4 v[32:35], v21, s[28:31], s56 offen sc1
  s_add_u32 s56, s56, 2048
  s_waitcnt lgkmcnt(8)
  buffer_store_dwordx4 v[36:39], v21, s[28:31], s56 offen sc1
  s_add_u32 s56, s56, 2048
  s_waitcnt lgkmcnt(6)
  buffer_store_dwordx4 v[40:43], v21, s[28:31], s56 offen sc1
  s_add_u32 s56, s56, 2048
  s_waitcnt lgkmcnt(4)
  buffer_store_dwordx4 v[44:47], v21, s[28:31], s56 offen sc1
  s_add_u32 s56, s56, 2048
  s_waitcnt lgkmcnt(2)
  buffer_store_dwordx4 v[48:51], v21, s[28:31], s56 offen sc1
  s_add_u32 s56, s56, 2048
  s_waitcnt lgkmcnt(0)
  buffer_store_dwordx4 v[52:55], v21, s[28:31], s56 offen sc1
  s_endpgm
L_ref_k16:
  s_lshr_b32 s52, s22, 2
  s_and_b32 s53, s22, 3
  s_lshl_b32 s55, s52, 2
  s_add_u32 s55, s55, s53
  v_lshrrev_b32 v10, 4, v1
  v_bfe_u32 v11, v1, 2, 2
  v_and_b32 v12, 1, v10
  v_lshl_or_b32 v12, v12, 2, v11
  s_add_u32 s46, s55, 0
  v_xor_b32 v12, s46, v12
  v_lshlrev_b32 v12, 5, v12
  v_lshl_add_u32 v13, v10, 3, v11
  v_lshl_add_u32 v12, v13, 8, v12
  v_and_b32 v13, 3, v1
  v_lshl_add_u32 v11, v13, 3, v12
  s_lshl_b32 s56, s49, 1
  s_add_u32 s56, s56, s52
  s_lshl_b32 s56, s56, 5
  s_add_u32 s56, s56, s53
  s_lshl_b32 s56, s56, 10
  ds_read_b64_tr_b16 v[24:25], v11 offset:0
  ds_read_b64_tr_b16 v[26:27], v11 offset:1024
  ds_read_b64_tr_b16 v[28:29], v11 offset:8192
  ds_read_b64_tr_b16 v[30:31], v11 offset:9216
  ds_read_b64_tr_b16 v[32:33], v11 offset:16384
  ds_read_b64_tr_b16 v[34:35], v11 offset:17408
  ds_read_b64_tr_b16 v[36:37], v11 offset:24576
  ds_read_b64_tr_b16 v[38:39], v11 offset:25600
  ds_read_b64_tr_b16 v[40:41], v11 offset:32768
  ds_read_b64_tr_b16 v[42:43], v11 offset:33792
  ds_read_b64_tr_b16 v[44:45], v11 offset:40960
  ds_read_b64_tr_b16 v[46:47], v11 offset:41984
  ds_read_b64_tr_b16 v[48:49], v11 offset:49152
  ds_read_b64_tr_b16 v[50:51], v11 offset:50176
  s_waitcnt lgkmcnt(12)
  ds_read_b64_tr_b16 v[52:53], v11 offset:57344
  ds_read_b64_tr_b16 v[54:55], v11 offset:58368
  buffer_store_dwordx4 v[24:27], v21, s[28:31], s56 offen sc1
  s_add_u32 s56, s56, 4096
  s_waitcnt lgkmcnt(12)
  buffer_store_dwordx4 v[28:31], v21, s[28:31], s56 offen sc1
  s_add_u32 s56, s56, 4096
  s_waitcnt lgkmcnt(10)
  buffer_store_dwordx4 v[32:35], v21, s[28:31], s56 offen sc1
  s_add_u32 s56, s56, 4096
  s_waitcnt lgkmcnt(8)
  buffer_store_dwordx4 v[36:39], v21, s[28:31], s56 offen sc1
  s_add_u32 s56, s56, 4096
  s_waitcnt lgkmcnt(6)
  buffer_store_dwordx4 v[40:43], v21, s[28:31], s56 offen sc1
  s_add_u32 s56, s56, 4096
  s_waitcnt lgkmcnt(4)
  buffer_store_dwordx4 v[44:47], v21, s[28:31], s56 offen sc1
  s_add_u32 s56, s56, 4096
  s_waitcnt lgkmcnt(2)
  buffer_store_dwordx4 v[48:51], v21, s[28:31], s56 offen sc1
  s_add_u32 s56, s56, 4096
  s_waitcnt lgkmcnt(0)
  buffer_store_dwordx4 v[52:55], v21, s[28:31], s56 offen sc1
  s_endpgm
L_prep_exit:
  s_endpgm
.section .rodata,"a"
.p2align 6
.amdhsa_kernel egnn_prep_kernel
  .amdhsa_next_free_vgpr 128
  .amdhsa_next_free_sgpr 102
  .amdhsa_accum_offset 128
  .amdhsa_group_segment_fixed_size 0
  .amdhsa_kernarg_size 88
  .amdhsa_user_sgpr_count 2
  .amdhsa_user_sgpr_kernarg_segment_ptr 1
  .amdhsa_system_sgpr_workgroup_id_x 1
  .amdhsa_float_denorm_mode_32 3
.end_amdhsa_kernel
.text
.globl egnn_main_kernel
.p2align 8
.type egnn_main_kernel,@function
egnn_main_kernel:
  s_cmp_ge_u32 s2, 250
  s_cbranch_scc1 L_main_exit
  s_load_dwordx2 s[4:5], s[0:1], 0
  s_load_dwordx2 s[6:7], s[0:1], 48
  s_load_dwordx2 s[8:9], s[0:1], 64
  s_load_dwordx2 s[10:11], s[0:1], 80
  v_mov_b32 v114, v0
  v_and_b32 v115, 63, v0
  v_lshrrev_b32 v1, 6, v0
  s_mul_i32 s13, s2, 40
  v_readfirstlane_b32 s12, v1
  v_lshlrev_b32 v159, 4, v115
  v_lshlrev_b32 v1, 2, v115
  v_lshrrev_b32 v3, 5, v115
  v_and_b32 v5, 31, v115
  s_lshl_b32 s70, s12, 1
  v_add_u32 v4, s70, v3
  v_xor_b32 v4, v4, v5
  v_lshlrev_b32 v4, 4, v4
  v_lshl_add_u32 v4, v3, 9, v4
  v_xor_b32 v5, 0x80, v4
  s_lshl_b32 s59, s12, 15
  s_mov_b32 s77, 0xffff0000
  s_mov_b32 s78, 0xbfb8aa3b
  s_mov_b32 s76, 0
  s_mov_b32 s74, 0
  s_lshl_b32 s70, s2, 8
  s_add_u32 s70, s70, 7340032
  s_mul_i32 s71, s2, 20480
  s_waitcnt lgkmcnt(0)
  s_add_u32 s44, s10, s70
  s_addc_u32 s45, s11, 0
  s_mov_b32 s46, 200
  s_mov_b32 s47, 0x20000
  buffer_load_dword v2, v1, s[44:47], 0 offen
  s_add_u32 s32, s4, s71
  s_addc_u32 s33, s5, 0
  s_mov_b32 s34, 20480
  s_mov_b32 s35, 0x20000
  s_lshl_b32 s70, s12, 10
  s_add_u32 s71, s70, 32768
  s_add_u32 m0, s71, 0
  s_add_u32 s72, s70, 0
  buffer_load_dwordx4 v4, s[32:35], s72 offen lds
  s_add_u32 m0, s71, 4096
  s_add_u32 s72, s70, 4096
  buffer_load_dwordx4 v5, s[32:35], s72 offen lds
  s_add_u32 m0, s71, 8192
  s_add_u32 s72, s70, 8192
  buffer_load_dwordx4 v4, s[32:35], s72 offen lds
  s_add_u32 m0, s71, 12288
  s_add_u32 s72, s70, 12288
  buffer_load_dwordx4 v5, s[32:35], s72 offen lds
  s_add_u32 m0, s71, 16384
  s_add_u32 s72, s70, 16384
  buffer_load_dwordx4 v4, s[32:35], s72 offen lds
  s_add_u32 s36, s10, 0x740000
  s_addc_u32 s37, s11, 0
  s_mov_b32 s38, 393216
  s_mov_b32 s39, 0x20000
  s_add_u32 s15, s59, 0
  buffer_load_dwordx4 a[0:3], v159, s[36:39], s15 offen offset:0
  buffer_load_dwordx4 a[4:7], v159, s[36:39], s15 offen offset:1024
  buffer_load_dwordx4 a[8:11], v159, s[36:39], s15 offen offset:2048
  buffer_load_dwordx4 a[12:15], v159, s[36:39], s15 offen offset:3072
  s_add_u32 s15, s59, 4096
  buffer_load_dwordx4 a[16:19], v159, s[36:39], s15 offen offset:0
  buffer_load_dwordx4 a[20:23], v159, s[36:39], s15 offen offset:1024
  buffer_load_dwordx4 a[24:27], v159, s[36:39], s15 offen offset:2048
  buffer_load_dwordx4 a[28:31], v159, s[36:39], s15 offen offset:3072
  s_add_u32 s15, s59, 8192
  buffer_load_dwordx4 a[32:35], v159, s[36:39], s15 offen offset:0
  buffer_load_dwordx4 a[36:39], v159, s[36:39], s15 offen offset:1024
  s_add_u32 s20, s10, 0x500000
  s_addc_u32 s21, s11, 0
  s_mov_b32 s22, 640000
  s_mov_b32 s23, 0x20000
  s_add_u32 s24, s10, 0x5a0000
  s_addc_u32 s25, s11, 0
  s_mov_b32 s26, 1280000
  s_mov_b32 s27, 0x20000
  s_add_u32 s28, s10, 0x720000
  s_addc_u32 s29, s11, 0
  s_mov_b32 s30, 80000
  s_mov_b32 s31, 0x20000
  s_add_u32 s16, s10, 0x400
  s_addc_u32 s17, s11, 0
  s_mov_b32 s18, 5123072
  s_mov_b32 s19, 0x20000
  v_mov_b32 v8, 0x7f000000
  v_mov_b32 v9, v8
  v_mov_b32 v10, v8
  v_mov_b32 v11, v8
  v_lshlrev_b32 v12, 4, v114
  v_add_u32 v12, 154624, v12
  ds_write_b128 v12, v[8:11]
  v_cmp_gt_u32 s[68:69], 16, v114
  v_mov_b32 v13, 0
  v_lshlrev_b32 v14, 2, v114
  v_add_u32 v14, 158976, v14
  s_mov_b64 exec, s[68:69]
  ds_write_b128 v12, v[8:11] offset:4096
  s_mov_b64 exec, -1
  v_cmp_gt_u32 s[68:69], 8, v114
  s_nop 3
  s_mov_b64 exec, s[68:69]
  ds_write_b32 v14, v13
  s_mov_b64 exec, -1
  v_and_b32 v8, 31, v115
  v_lshrrev_b32 v9, 5, v115
  v_and_b32 v10, 15, v115
  v_xor_b32 v9, v9, v10
  v_lshlrev_b32 v8, 9, v8
  v_add_u32 v8, 32768, v8
  v_xor_b32 v11, 0, v9
  v_lshl_add_u32 v190, v11, 4, v8
  v_xor_b32 v11, 2, v9
  v_lshl_add_u32 v191, v11, 4, v8
  v_xor_b32 v11, 4, v9
  v_lshl_add_u32 v192, v11, 4, v8
  v_xor_b32 v11, 6, v9
  v_lshl_add_u32 v193, v11, 4, v8
  v_xor_b32 v11, 8, v9
  v_lshl_add_u32 v194, v11, 4, v8
  v_xor_b32 v11, 10, v9
  v_lshl_add_u32 v195, v11, 4, v8
  v_xor_b32 v11, 12, v9
  v_lshl_add_u32 v196, v11, 4, v8
  v_xor_b32 v11, 14, v9
  v_lshl_add_u32 v197, v11, 4, v8
  v_mov_b32 v8, 0
  v_mov_b32 v9, 0
  v_mov_b32 v10, 0
  v_mov_b32 v11, 0
  v_lshlrev_b32 v12, 4, v114
  v_add_u32 v12, 65536, v12
  v_add_u32 v13, 0xc000, v12
  ds_write_b128 v12, v[8:11] offset:0
  ds_write_b128 v12, v[8:11] offset:4096
  ds_write_b128 v12, v[8:11] offset:8192
  ds_write_b128 v12, v[8:11] offset:12288
  ds_write_b128 v12, v[8:11] offset:16384
  ds_write_b128 v12, v[8:11] offset:20480
  ds_write_b128 v12, v[8:11] offset:24576
  ds_write_b128 v12, v[8:11] offset:28672
  ds_write_b128 v12, v[8:11] offset:32768
  ds_write_b128 v12, v[8:11] offset:36864
  s_waitcnt vmcnt(15)
  v_lshrrev_b32 v156, 16, v2
  v_and_b32 v8, 0xffff, v2
  v_mov_b32 v9, v156
  v_mul_u32_u24 v158, 3200, v115
  v_add_u32 v158, v158, v8
  v_add_u32_dpp v9, v9, v9 row_shr:1 row_mask:0xf bank_mask:0xf bound_ctrl:0
  s_nop 1
  v_add_u32_dpp v9, v9, v9 row_shr:2 row_mask:0xf bank_mask:0xf bound_ctrl:0
  s_nop 1
  v_add_u32_dpp v9, v9, v9 row_shr:4 row_mask:0xf bank_mask:0xf bound_ctrl:0
  s_nop 1
  v_add_u32_dpp v9, v9, v9 row_shr:8 row_mask:0xf bank_mask:0xf bound_ctrl:0
  s_nop 1
  v_add_u32_dpp v9, v9, v9 row_bcast:15 row_mask:0xa bank_mask:0xf
  s_nop 1
  v_add_u32_dpp v9, v9, v9 row_bcast:31 row_mask:0xc bank_mask:0xf
  s_nop 1
  v_readlane_b32 s57, v9, 63
  v_sub_u32 v157, v9, v156
  s_nop 1
  s_cmp_gt_u32 s57, 768
  s_cselect_b32 s76, 1, 0
  s_cselect_b32 s75, 0, s57
  v_subrev_u32 v8, s74, v157
  v_sub_u32 v9, 0, v8
  v_max_i32 v9, 0, v9
  v_sub_u32 v10, s75, v8
  v_min_i32 v10, v10, v156
  v_add_u32 v9, s12, v9
  v_add_u32 v11, v9, v158
  v_add_u32 v12, v9, v8
  v_lshlrev_b32 v12, 2, v12
L_desc_1:
  v_cmp_lt_i32 vcc, v9, v10
  v_add_u32 v9, 4, v9
  s_and_b64 exec, exec, vcc
  s_cbranch_scc0 L_desc_done_2
  ds_write_b32 v12, v11 offset:0
  v_add_u32 v11, 4, v11
  v_add_u32 v12, 16, v12
  s_branch L_desc_1
L_desc_done_2:
  s_mov_b64 exec, -1
  s_waitcnt lgkmcnt(0)
  s_waitcnt vmcnt(10)
  s_barrier
  ds_read_b128 a[176:179], v190 offset:0
  ds_read_b128 a[180:183], v190 offset:16384
  s_waitcnt vmcnt(8) lgkmcnt(0)
  ds_read_b128 a[184:187], v191 offset:0
  ds_read_b128 a[188:191], v191 offset:16384
  v_mfma_f32_32x32x16_bf16 v[0:15], a[176:179], a[0:3], 0
  buffer_load_dwordx4 a[40:43], v159, s[36:39], s15 offen offset:2048
  buffer_load_dwordx4 a[44:47], v159, s[36:39], s15 offen offset:3072
  s_add_u32 s15, s59, 12288
  buffer_load_dwordx4 a[48:51], v159, s[36:39], s15 offen offset:0
  v_lshlrev_b32 v205, 2, v114
  ds_read_b32 v206, v205 offset:0
  ds_read_b32 v207, v205 offset:1024
  ds_read_b32 v208, v205 offset:2048
  v_mfma_f32_32x32x16_bf16 v[32:47], a[180:183], a[0:3], 0
  s_sub_i32 s70, s75, 0
  v_cmp_gt_i32 s[62:63], s70, v114
  s_sub_i32 s70, s75, 256
  v_cmp_gt_i32 s[64:65], s70, v114
  v_mfma_f32_32x32x16_bf16 v[16:31], a[176:179], a[4:7], 0
  buffer_load_dwordx4 a[52:55], v159, s[36:39], s15 offen offset:1024
  s_sub_i32 s70, s75, 512
  v_cmp_gt_i32 s[66:67], s70, v114
  v_mov_b32 v209, 0x0fffffff
  s_waitcnt lgkmcnt(0)
  v_mfma_f32_32x32x16_bf16 v[48:63], a[180:183], a[4:7], 0
  v_cndmask_b32 v206, v209, v206, s[62:63]
  v_lshlrev_b32 v210, 2, v206
  v_lshlrev_b32 v211, 3, v206
  buffer_load_dword v160, v210, s[20:23], 0 offen
  s_waitcnt vmcnt(11)
  ds_read_b128 a[176:179], v192 offset:0
  ds_read_b128 a[180:183], v192 offset:16384
  v_mfma_f32_32x32x16_bf16 v[0:15], a[184:187], a[8:11], v[0:15]
  buffer_load_dwordx4 a[56:59], v159, s[36:39], s15 offen offset:2048
  buffer_load_dwordx2 v[162:163], v211, s[24:27], 0 offen
  v_cndmask_b32 v207, v209, v207, s[64:65]
  v_lshlrev_b32 v210, 2, v207
  v_lshlrev_b32 v211, 3, v207
  v_mfma_f32_32x32x16_bf16 v[32:47], a[188:191], a[8:11], v[32:47]
  buffer_load_dword v170, v210, s[20:23], 0 offen
  buffer_load_dwordx2 v[172:173], v211, s[24:27], 0 offen
  v_cndmask_b32 v208, v209, v208, s[66:67]
  v_lshlrev_b32 v210, 2, v208
  v_mfma_f32_32x32x16_bf16 v[16:31], a[184:187], a[12:15], v[16:31]
  buffer_load_dwordx4 a[60:63], v159, s[36:39], s15 offen offset:3072
  v_lshlrev_b32 v211, 3, v208
  buffer_load_dword v180, v210, s[20:23], 0 offen
  buffer_load_dwordx2 v[182:183], v211, s[24:27], 0 offen
  v_mov_b32 v222, 0
  v_mfma_f32_32x32x16_bf16 v[48:63], a[188:191], a[12:15], v[48:63]
  v_mov_b32 v223, 0
  v_mov_b32 v224, 0
  v_mov_b32 v225, 0
  v_lshlrev_b32 v226, 4, v114
  s_waitcnt vmcnt(16) lgkmcnt(0)
  ds_read_b128 a[184:187], v193 offset:0
  ds_read_b128 a[188:191], v193 offset:16384
  v_mfma_f32_32x32x16_bf16 v[0:15], a[176:179], a[16:19], v[0:15]
  s_add_u32 s15, s59, 16384
  buffer_load_dwordx4 a[64:67], v159, s[36:39], s15 offen offset:0
  v_add_u32 v226, 65536, v226
  v_add_u32 v227, 0xc000, v226
  ds_write_b128 v226, v[222:225] offset:40960
  ds_write_b128 v226, v[222:225] offset:45056
  v_mfma_f32_32x32x16_bf16 v[32:47], a[180:183], a[16:19], v[32:47]
  ds_write_b128 v227, v[222:225] offset:0
  ds_write_b128 v227, v[222:225] offset:4096
  ds_write_b128 v227, v[222:225] offset:8192
  ds_write_b128 v227, v[222:225] offset:12288
  v_mfma_f32_32x32x16_bf16 v[16:31], a[176:179], a[20:23], v[16:31]
  buffer_load_dwordx4 a[68:71], v159, s[36:39], s15 offen offset:1024
  ds_write_b128 v227, v[222:225] offset:16384
  ds_write_b128 v227, v[222:225] offset:20480
  ds_write_b128 v227, v[222:225] offset:24576
  ds_write_b128 v227, v[222:225] offset:28672
  v_mfma_f32_32x32x16_bf16 v[48:63], a[180:183], a[20:23], v[48:63]
  ds_write_b128 v227, v[222:225] offset:32768
  v_cmp_gt_u32 vcc, 192, v114
  s_nop 3
  s_mov_b64 s[68:69], vcc
  s_waitcnt vmcnt(16) lgkmcnt(11)
  ds_read_b128 a[176:179], v194 offset:0
  ds_read_b128 a[180:183], v194 offset:16384
  v_mfma_f32_32x32x16_bf16 v[0:15], a[184:187], a[24:27], v[0:15]
  buffer_load_dwordx4 a[72:75], v159, s[36:39], s15 offen offset:2048
  s_mov_b64 exec, s[68:69]
  ds_write_b128 v227, v[222:225] offset:36864
  s_mov_b64 exec, -1
  s_add_u32 s44, s10, 0x7a0000
  s_addc_u32 s45, s11, 0
  s_mov_b32 s46, 4096
  s_mov_b32 s47, 0x20000
  v_lshlrev_b32 v205, 3, v115
  s_lshl_b32 s70, s12, 10
  v_mfma_f32_32x32x16_bf16 v[32:47], a[188:191], a[24:27], v[32:47]
  buffer_load_dwordx2 v[232:233], v205, s[44:47], s70 offen offset:0
  buffer_load_dwordx2 v[234:235], v205, s[44:47], s70 offen offset:512
  v_mov_b32 v208, 1
  v_mov_b32 v209, 158976
  v_mfma_f32_32x32x16_bf16 v[16:31], a[184:187], a[28:31], v[16:31]
  buffer_load_dwordx4 a[76:79], v159, s[36:39], s15 offen offset:3072
  s_lshl_b32 s71, s13, 3
  s_waitcnt vmcnt(11)
  v_bfe_u32 v205, v160, 3, 3
  v_lshl_add_u32 v205, v205, 2, v209
  v_mfma_f32_32x32x16_bf16 v[48:63], a[188:191], a[28:31], v[48:63]
  v_lshrrev_b32 v206, 9, v160
  v_lshlrev_b32 v206, 3, v206
  v_and_b32 v207, 63, v160
  v_lshlrev_b32 v207, 3, v207
  s_waitcnt lgkmcnt(1)
  ds_read_b128 a[184:187], v195 offset:0
  ds_read_b128 a[188:191], v195 offset:16384
  v_mfma_f32_32x32x16_bf16 v[0:15], a[176:179], a[32:35], v[0:15]
  s_add_u32 s15, s59, 20480
  buffer_load_dwordx4 a[80:83], v159, s[36:39], s15 offen offset:0
  s_mov_b64 exec, s[62:63]
  ds_add_rtn_u32 v161, v205, v208
  s_mov_b64 exec, -1
  buffer_load_dwordx2 v[166:167], v206, s[28:31], 0 offen
  buffer_load_dwordx2 v[168:169], v207, s[28:31], s71 offen
  s_waitcnt vmcnt(12)
  v_mfma_f32_32x32x16_bf16 v[32:47], a[180:183], a[32:35], v[32:47]
  v_bfe_u32 v205, v170, 3, 3
  v_lshl_add_u32 v205, v205, 2, v209
  v_lshrrev_b32 v206, 9, v170
  v_lshlrev_b32 v206, 3, v206
  v_mfma_f32_32x32x16_bf16 v[16:31], a[176:179], a[36:39], v[16:31]
  buffer_load_dwordx4 a[84:87], v159, s[36:39], s15 offen offset:1024
  v_and_b32 v207, 63, v170
  v_lshlrev_b32 v207, 3, v207
  s_mov_b64 exec, s[64:65]
  ds_add_rtn_u32 v171, v205, v208
  s_mov_b64 exec, -1
  buffer_load_dwordx2 v[176:177], v206, s[28:31], 0 offen
  v_mfma_f32_32x32x16_bf16 v[48:63], a[180:183], a[36:39], v[48:63]
  buffer_load_dwordx2 v[178:179], v207, s[28:31], s71 offen
  s_waitcnt vmcnt(12)
  v_bfe_u32 v205, v180, 3, 3
  v_lshl_add_u32 v205, v205, 2, v209
  s_waitcnt lgkmcnt(2)
  ds_read_b128 a[176:179], v196 offset:0
  ds_read_b128 a[180:183], v196 offset:16384
  v_mfma_f32_32x32x16_bf16 v[0:15], a[184:187], a[40:43], v[0:15]
  buffer_load_dwordx4 a[88:91], v159, s[36:39], s15 offen offset:2048
  v_lshrrev_b32 v206, 9, v180
  v_lshlrev_b32 v206, 3, v206
  v_and_b32 v207, 63, v180
  v_lshlrev_b32 v207, 3, v207
  v_mfma_f32_32x32x16_bf16 v[32:47], a[188:191], a[40:43], v[32:47]
  s_mov_b64 exec, s[66:67]
  ds_add_rtn_u32 v181, v205, v208
  s_mov_b64 exec, -1
  buffer_load_dwordx2 v[186:187], v206, s[28:31], 0 offen
  buffer_load_dwordx2 v[188:189], v207, s[28:31], s71 offen
  v_and_b32 v213, 7, v115
  v_mfma_f32_32x32x16_bf16 v[16:31], a[184:187], a[44:47], v[16:31]
  buffer_load_dwordx4 a[92:95], v159, s[36:39], s15 offen offset:3072
  v_lshrrev_b32 v214, 4, v115
  v_xor_b32 v213, v213, v214
  v_lshlrev_b32 v213, 4, v213
  v_xor_b32 v214, 64, v213
  v_mfma_f32_32x32x16_bf16 v[48:63], a[188:191], a[44:47], v[48:63]
  v_add_u32 v104, 3072, v213
  v_add_u32 v105, 2048, v214
  v_add_u32 v106, 1024, v213
  v_mov_b32 v107, v214
  s_waitcnt lgkmcnt(1)
  ds_read_b128 a[184:187], v197 offset:0
  ds_read_b128 a[188:191], v197 offset:16384
  v_mfma_f32_32x32x16_bf16 v[0:15], a[176:179], a[48:51], v[0:15]
  s_add_u32 s15, s59, 24576
  buffer_load_dwordx4 a[96:99], v159, s[36:39], s15 offen offset:0
  s_lshl_b32 s52, s12, 7
  s_lshl_b32 s70, s12, 12
  s_add_u32 s48, s70, 0
  s_add_u32 s49, s70, 16384
  v_mfma_f32_32x32x16_bf16 v[32:47], a[180:183], a[48:51], v[32:47]
  s_add_u32 s50, s70, 32768
  s_add_u32 s51, s70, 49152
  v_lshrrev_b32 v113, 3, v115
  v_lshlrev_b32 v113, 4, v113
  v_mfma_f32_32x32x16_bf16 v[16:31], a[176:179], a[52:55], v[16:31]
  buffer_load_dwordx4 a[100:103], v159, s[36:39], s15 offen offset:1024
  v_add_u32 v113, 154624, v113
  v_add_u32 v112, 65536, v159
  v_mfma_f32_32x32x16_bf16 v[48:63], a[180:183], a[52:55], v[48:63]
  s_waitcnt lgkmcnt(0)
  ds_read_b128 a[176:179], v190 offset:256
  ds_read_b128 a[180:183], v190 offset:16640
  v_mfma_f32_32x32x16_bf16 v[0:15], a[184:187], a[56:59], v[0:15]
  buffer_load_dwordx4 a[104:107], v159, s[36:39], s15 offen offset:2048
  s_waitcnt lgkmcnt(0)
  s_barrier
  v_min_u32 v205, 7, v115
  v_lshlrev_b32 v205, 2, v205
  v_mfma_f32_32x32x16_bf16 v[32:47], a[188:191], a[56:59], v[32:47]
  v_add_u32 v205, 158976, v205
  ds_read_b32 v206, v205
  v_cmp_gt_u32 vcc, 5, v115
  s_waitcnt lgkmcnt(0)
  v_mfma_f32_32x32x16_bf16 v[16:31], a[184:187], a[60:63], v[16:31]
  buffer_load_dwordx4 a[108:111], v159, s[36:39], s15 offen offset:3072
  v_add_u32 v206, 31, v206
  v_lshrrev_b32 v206, 5, v206
  v_max_u32 v206, 1, v206
  v_cndmask_b32 v206, 0, v206, vcc
  v_mfma_f32_32x32x16_bf16 v[48:63], a[188:191], a[60:63], v[48:63]
  v_mov_b32 v207, v206
  s_nop 1
  v_add_u32_dpp v207, v207, v207 row_shr:1 row_mask:0xf bank_mask:0xf bound_ctrl:0
  s_nop 1
  v_add_u32_dpp v207, v207, v207 row_shr:2 row_mask:0xf bank_mask:0xf bound_ctrl:0
  s_nop 1
  s_waitcnt vmcnt(18)
  ds_read_b128 a[184:187], v191 offset:256
  ds_read_b128 a[188:191], v191 offset:16640
  v_mfma_f32_32x32x16_bf16 v[0:15], a[176:179], a[64:67], v[0:15]
  s_add_u32 s15, s59, 28672
  buffer_load_dwordx4 a[112:115], v159, s[36:39], s15 offen offset:0
  v_add_u32_dpp v207, v207, v207 row_shr:4 row_mask:0xf bank_mask:0xf bound_ctrl:0
  s_nop 1
  v_sub_u32 v208, v207, v206
  v_lshlrev_b32 v208, 5, v208
  s_mov_b32 s53, 0
  v_mfma_f32_32x32x16_bf16 v[32:47], a[180:183], a[64:67], v[32:47]
  v_readlane_b32 s70, v207, 0
  s_nop 0
  s_lshl_b32 s70, 1, s70
  s_or_b32 s53, s53, s70
  v_mfma_f32_32x32x16_bf16 v[16:31], a[176:179], a[68:71], v[16:31]
  buffer_load_dwordx4 a[116:119], v159, s[36:39], s15 offen offset:1024
  v_readlane_b32 s70, v207, 1
  s_nop 0
  s_lshl_b32 s70, 1, s70
  s_or_b32 s53, s53, s70
  v_mfma_f32_32x32x16_bf16 v[48:63], a[180:183], a[68:71], v[48:63]
  v_readlane_b32 s70, v207, 2
  s_nop 0
  s_lshl_b32 s70, 1, s70
  s_or_b32 s53, s53, s70
  s_waitcnt vmcnt(16) lgkmcnt(0)
  ds_read_b128 a[176:179], v192 offset:256
  ds_read_b128 a[180:183], v192 offset:16640
  v_mfma_f32_32x32x16_bf16 v[0:15], a[184:187], a[72:75], v[0:15]
  buffer_load_dwordx4 a[120:123], v159, s[36:39], s15 offen offset:2048
  v_readlane_b32 s70, v207, 3
  s_nop 0
  s_lshl_b32 s70, 1, s70
  s_or_b32 s53, s53, s70
  v_mfma_f32_32x32x16_bf16 v[32:47], a[188:191], a[72:75], v[32:47]
  v_readlane_b32 s70, v207, 4
  s_nop 0
  s_max_u32 s70, s70, 6
  s_lshl_b32 s70, 1, s70
  v_mfma_f32_32x32x16_bf16 v[16:31], a[184:187], a[76:79], v[16:31]
  buffer_load_dwordx4 a[124:127], v159, s[36:39], s15 offen offset:3072
  s_or_b32 s53, s53, s70
  v_bfe_u32 v209, v160, 3, 3
  v_lshlrev_b32 v209, 2, v209
  ds_bpermute_b32 v213, v209, v208
  v_mfma_f32_32x32x16_bf16 v[48:63], a[188:191], a[76:79], v[48:63]
  v_bfe_u32 v210, v170, 3, 3
  v_lshlrev_b32 v210, 2, v210
  ds_bpermute_b32 v214, v210, v208
  v_bfe_u32 v211, v180, 3, 3
  s_waitcnt vmcnt(14) lgkmcnt(2)
  ds_read_b128 a[184:187], v193 offset:256
  ds_read_b128 a[188:191], v193 offset:16640
  v_mfma_f32_32x32x16_bf16 v[0:15], a[176:179], a[80:83], v[0:15]
  v_lshlrev_b32 v211, 2, v211
  ds_bpermute_b32 v215, v211, v208
  s_waitcnt lgkmcnt(4)
  v_add_u32 v161, v161, v213
  v_mfma_f32_32x32x16_bf16 v[32:47], a[180:183], a[80:83], v[32:47]
  v_lshrrev_b32 v217, 5, v161
  v_and_b32 v218, 7, v161
  v_lshlrev_b32 v218, 4, v218
  v_lshl_add_u32 v217, v217, 7, v218
  v_mfma_f32_32x32x16_bf16 v[16:31], a[176:179], a[84:87], v[16:31]
  v_bfe_u32 v218, v161, 3, 2
  v_lshl_add_u32 v217, v218, 2, v217
  v_add_u32 v217, 154624, v217
  v_and_b32 v218, 0xfffffe00, v160
  v_mfma_f32_32x32x16_bf16 v[48:63], a[180:183], a[84:87], v[48:63]
  s_mov_b64 exec, s[62:63]
  ds_write_b32 v217, v218
  s_mov_b64 exec, -1
  s_waitcnt lgkmcnt(4)
  v_add_u32 v171, v171, v214
  v_lshrrev_b32 v217, 5, v171
  s_waitcnt vmcnt(8) lgkmcnt(2)
  ds_read_b128 a[176:179], v194 offset:256
  ds_read_b128 a[180:183], v194 offset:16640
  v_mfma_f32_32x32x16_bf16 v[0:15], a[184:187], a[88:91], v[0:15]
  v_and_b32 v218, 7, v171
  v_lshlrev_b32 v218, 4, v218
  v_lshl_add_u32 v217, v217, 7, v218
  v_bfe_u32 v218, v171, 3, 2
  v_mfma_f32_32x32x16_bf16 v[32:47], a[188:191], a[88:91], v[32:47]
  v_lshl_add_u32 v217, v218, 2, v217
  v_add_u32 v217, 154624, v217
  v_and_b32 v218, 0xfffffe00, v170
  s_mov_b64 exec, s[64:65]
  ds_write_b32 v217, v218
  s_mov_b64 exec, -1
  v_mfma_f32_32x32x16_bf16 v[16:31], a[184:187], a[92:95], v[16:31]
  s_waitcnt lgkmcnt(4)
  v_add_u32 v181, v181, v215
  v_lshrrev_b32 v217, 5, v181
  v_and_b32 v218, 7, v181
  v_mfma_f32_32x32x16_bf16 v[48:63], a[188:191], a[92:95], v[48:63]
  v_lshlrev_b32 v218, 4, v218
  v_lshl_add_u32 v217, v217, 7, v218
  v_bfe_u32 v218, v181, 3, 2
  v_lshl_add_u32 v217, v218, 2, v217
  s_waitcnt vmcnt(6) lgkmcnt(1)
  ds_read_b128 a[184:187], v195 offset:256
  ds_read_b128 a[188:191], v195 offset:16640
  v_mfma_f32_32x32x16_bf16 v[0:15], a[176:179], a[96:99], v[0:15]
  v_add_u32 v217, 154624, v217
  v_and_b32 v218, 0xfffffe00, v180
  s_mov_b64 exec, s[66:67]
  ds_write_b32 v217, v218
  s_mov_b64 exec, -1
  v_mfma_f32_32x32x16_bf16 v[32:47], a[180:183], a[96:99], v[32:47]
  v_mfma_f32_32x32x16_bf16 v[16:31], a[176:179], a[100:103], v[16:31]
  s_waitcnt lgkmcnt(0)
  s_barrier
  ds_read_b128 v[96:99], v113 offset:0
  v_mfma_f32_32x32x16_bf16 v[48:63], a[180:183], a[100:103], v[48:63]
  s_waitcnt lgkmcnt(0)
  v_add_u32 v100, v96, v104
  v_add_u32 v101, v97, v105
  v_add_u32 v102, v98, v106
  s_waitcnt vmcnt(4)
  ds_read_b128 a[176:179], v196 offset:256
  ds_read_b128 a[180:183], v196 offset:16640
  v_mfma_f32_32x32x16_bf16 v[0:15], a[184:187], a[104:107], v[0:15]
  v_add_u32 v103, v99, v107
  s_mov_b32 m0, s48
  s_nop 0
  buffer_load_dwordx4 v100, s[16:19], s52 offen offset:0 lds
  buffer_load_dwordx4 v101, s[16:19], s52 offen offset:1024 lds
  v_mfma_f32_32x32x16_bf16 v[32:47], a[188:191], a[104:107], v[32:47]
  buffer_load_dwordx4 v102, s[16:19], s52 offen offset:2048 lds
  buffer_load_dwordx4 v103, s[16:19], s52 offen offset:3072 lds
  ds_read_b128 v[96:99], v113 offset:128
  s_waitcnt lgkmcnt(0)
  v_mfma_f32_32x32x16_bf16 v[16:31], a[184:187], a[108:111], v[16:31]
  v_add_u32 v100, v96, v104
  v_add_u32 v101, v97, v105
  v_add_u32 v102, v98, v106
  v_add_u32 v103, v99, v107
  v_mfma_f32_32x32x16_bf16 v[48:63], a[188:191], a[108:111], v[48:63]
  s_mov_b32 m0, s49
  s_nop 0
  buffer_load_dwordx4 v100, s[16:19], s52 offen offset:0 lds
  buffer_load_dwordx4 v101, s[16:19], s52 offen offset:1024 lds
  buffer_load_dwordx4 v102, s[16:19], s52 offen offset:2048 lds
  s_waitcnt vmcnt(9)
  ds_read_b128 a[184:187], v197 offset:256
  ds_read_b128 a[188:191], v197 offset:16640
  v_mfma_f32_32x32x16_bf16 v[0:15], a[176:179], a[112:115], v[0:15]
  buffer_load_dwordx4 v103, s[16:19], s52 offen offset:3072 lds
  v_mov_b32 v220, 0x3f80
  v_lshlrev_b32 v205, 16, v166
  v_mfma_f32_32x32x16_bf16 v[32:47], a[180:183], a[112:115], v[32:47]
  v_and_b32 v206, s77, v166
  v_lshlrev_b32 v207, 16, v167
  v_lshlrev_b32 v208, 16, v168
  v_and_b32 v209, s77, v168
  v_mfma_f32_32x32x16_bf16 v[16:31], a[176:179], a[116:119], v[16:31]
  v_lshlrev_b32 v210, 16, v169
  v_sub_f32 v205, v208, v205
  v_sub_f32 v206, v209, v206
  v_sub_f32 v207, v210, v207
  v_mfma_f32_32x32x16_bf16 v[48:63], a[180:183], a[116:119], v[48:63]
  v_cvt_pk_bf16_f32 v166, v205, v206
  v_cvt_pk_bf16_f32 v167, v207, v207
  v_lshrrev_b32 v211, 5, v161
  v_mul_u32_u24 v211, 3072, v211
  s_waitcnt vmcnt(8) lgkmcnt(0)
  v_mfma_f32_32x32x16_bf16 v[0:15], a[184:187], a[120:123], v[0:15]
  v_add_u32 v211, 65536, v211
  v_lshlrev_b32 v205, 16, v166
  v_and_b32 v206, s77, v166
  v_lshlrev_b32 v207, 16, v167
  v_mfma_f32_32x32x16_bf16 v[32:47], a[188:191], a[120:123], v[32:47]
  v_mul_f32 v207, v207, v207
  v_fmac_f32 v207, v206, v206
  v_fmac_f32 v207, v205, v205
  v_and_b32 v212, 31, v161
  v_mfma_f32_32x32x16_bf16 v[16:31], a[184:187], a[124:127], v[16:31]
  v_and_b32 v213, 7, v160
  v_cvt_pk_bf16_f32 v164, v207, v207
  v_mov_b32 v165, v162
  v_lshl_add_u32 v214, v212, 4, v211
  v_mfma_f32_32x32x16_bf16 v[48:63], a[188:191], a[124:127], v[48:63]
  v_lshl_add_u32 v215, v213, 1, v214
  v_bfe_u32 v216, v212, 4, 1
  v_lshl_add_u32 v217, v216, 10, v211
  v_bfe_u32 v216, v212, 2, 1
  v_lshl_add_u32 v217, v216, 9, v217
  v_and_b32 v216, 8, v212
  v_add_u32 v217, v216, v217
  v_and_b32 v216, 3, v212
  v_lshl_add_u32 v217, v216, 1, v217
  v_lshl_add_u32 v217, v213, 6, v217
  s_mov_b64 exec, s[62:63]
  ds_write_b128 v214, v[162:165]
  ds_write_b16 v215, v220 offset:512
  ds_write_b16 v217, v220 offset:1024
  ds_write_b16 v217, v166 offset:1040
  ds_write_b16_d16_hi v217, v166 offset:1056
  ds_write_b16 v217, v167 offset:1072
  s_mov_b64 exec, -1
  v_lshlrev_b32 v205, 16, v176
  v_and_b32 v206, s77, v176
  v_lshlrev_b32 v207, 16, v177
  v_lshlrev_b32 v208, 16, v178
  v_and_b32 v209, s77, v178
  v_lshlrev_b32 v210, 16, v179
  v_sub_f32 v205, v208, v205
  v_sub_f32 v206, v209, v206
  v_sub_f32 v207, v210, v207
  v_cvt_pk_bf16_f32 v176, v205, v206
  v_cvt_pk_bf16_f32 v177, v207, v207
  v_lshrrev_b32 v211, 5, v171
  v_mul_u32_u24 v211, 3072, v211
  v_add_u32 v211, 65536, v211
  v_lshlrev_b32 v205, 16, v176
  v_and_b32 v206, s77, v176
  v_lshlrev_b32 v207, 16, v177
  v_mul_f32 v207, v207, v207
  v_fmac_f32 v207, v206, v206
  v_fmac_f32 v207, v205, v205
  v_and_b32 v212, 31, v171
  v_and_b32 v213, 7, v170
  v_cvt_pk_bf16_f32 v174, v207, v207
  v_mov_b32 v175, v172
  v_lshl_add_u32 v214, v212, 4, v211
  v_lshl_add_u32 v215, v213, 1, v214
  v_bfe_u32 v216, v212, 4, 1
  v_lshl_add_u32 v217, v216, 10, v211
  v_bfe_u32 v216, v212, 2, 1
  v_lshl_add_u32 v217, v216, 9, v217
  v_and_b32 v216, 8, v212
  v_add_u32 v217, v216, v217
  v_and_b32 v216, 3, v212
  v_lshl_add_u32 v217, v216, 1, v217
  v_lshl_add_u32 v217, v213, 6, v217
  s_mov_b64 exec, s[64:65]
  ds_write_b128 v214, v[172:175]
  ds_write_b16 v215, v220 offset:512
  ds_write_b16 v217, v220 offset:1024
  ds_write_b16 v217, v176 offset:1040
  ds_write_b16_d16_hi v217, v176 offset:1056
  ds_write_b16 v217, v177 offset:1072
  s_mov_b64 exec, -1
  v_lshlrev_b32 v205, 16, v186
  v_and_b32 v206, s77, v186
  v_lshlrev_b32 v207, 16, v187
  v_lshlrev_b32 v208, 16, v188
  v_and_b32 v209, s77, v188
  v_lshlrev_b32 v210, 16, v189
  v_sub_f32 v205, v208, v205
  v_sub_f32 v206, v209, v206
  v_sub_f32 v207, v210, v207
  v_cvt_pk_bf16_f32 v186, v205, v206
  v_cvt_pk_bf16_f32 v187, v207, v207
  v_lshrrev_b32 v211, 5, v181
  v_mul_u32_u24 v211, 3072, v211
  v_add_u32 v211, 65536, v211
  v_lshlrev_b32 v205, 16, v186
  v_and_b32 v206, s77, v186
  v_lshlrev_b32 v207, 16, v187
  v_mul_f32 v207, v207, v207
  v_fmac_f32 v207, v206, v206
  v_fmac_f32 v207, v205, v205
  v_and_b32 v212, 31, v181
  v_and_b32 v213, 7, v180
  v_cvt_pk_bf16_f32 v184, v207, v207
  v_mov_b32 v185, v182
  v_lshl_add_u32 v214, v212, 4, v211
  v_lshl_add_u32 v215, v213, 1, v214
  v_bfe_u32 v216, v212, 4, 1
  v_lshl_add_u32 v217, v216, 10, v211
  v_bfe_u32 v216, v212, 2, 1
  v_lshl_add_u32 v217, v216, 9, v217
  v_and_b32 v216, 8, v212
  v_add_u32 v217, v216, v217
  v_and_b32 v216, 3, v212
  v_lshl_add_u32 v217, v216, 1, v217
  v_lshl_add_u32 v217, v213, 6, v217
  s_mov_b64 exec, s[66:67]
  ds_write_b128 v214, v[182:185]
  ds_write_b16 v215, v220 offset:512
  ds_write_b16 v217, v220 offset:1024
  ds_write_b16 v217, v186 offset:1040
  ds_write_b16_d16_hi v217, v186 offset:1056
  ds_write_b16 v217, v187 offset:1072
  s_mov_b64 exec, -1
  v_and_b32 v205, 31, v115
  v_lshrrev_b32 v206, 5, v115
  v_lshlrev_b32 v207, 3, v206
  v_sub_u32 v207, v205, v207
  v_mov_b32 v208, 0x3f80
  v_mov_b32 v209, 0x3f800000
  v_mov_b32 v211, 0
  v_cmp_eq_u32 vcc, 0, v207
  v_cmp_eq_u32 s[68:69], 1, v207
  s_nop 1
  v_cndmask_b32 v210, v211, v208, vcc
  v_cndmask_b32 v210, v210, v209, s[68:69]
  v_accvgpr_write_b32 a204, v210
  v_cmp_eq_u32 vcc, 2, v207
  v_cmp_eq_u32 s[68:69], 3, v207
  s_nop 1
  v_cndmask_b32 v210, v211, v208, vcc
  v_cndmask_b32 v210, v210, v209, s[68:69]
  v_accvgpr_write_b32 a205, v210
  v_cmp_eq_u32 vcc, 4, v207
  v_cmp_eq_u32 s[68:69], 5, v207
  s_nop 1
  v_cndmask_b32 v210, v211, v208, vcc
  v_cndmask_b32 v210, v210, v209, s[68:69]
  v_accvgpr_write_b32 a206, v210
  v_cmp_eq_u32 vcc, 6, v207
  v_cmp_eq_u32 s[68:69], 7, v207
  s_nop 1
  v_cndmask_b32 v210, v211, v208, vcc
  v_cndmask_b32 v210, v210, v209, s[68:69]
  v_accvgpr_write_b32 a207, v210
  v_cmp_eq_u32 vcc, 16, v207
  v_cmp_eq_u32 s[68:69], 17, v207
  s_nop 1
  v_cndmask_b32 v210, v211, v208, vcc
  v_cndmask_b32 v210, v210, v209, s[68:69]
  v_accvgpr_write_b32 a208, v210
  v_cmp_eq_u32 vcc, 18, v207
  v_cmp_eq_u32 s[68:69], 19, v207
  s_nop 1
  v_cndmask_b32 v210, v211, v208, vcc
  v_cndmask_b32 v210, v210, v209, s[68:69]
  v_accvgpr_write_b32 a209, v210
  v_cmp_eq_u32 vcc, 20, v207
  v_cmp_eq_u32 s[68:69], 21, v207
  s_nop 1
  v_cndmask_b32 v210, v211, v208, vcc
  v_cndmask_b32 v210, v210, v209, s[68:69]
  v_accvgpr_write_b32 a210, v210
  v_cmp_eq_u32 vcc, 22, v207
  v_cmp_eq_u32 s[68:69], 23, v207
  s_nop 1
  v_cndmask_b32 v210, v211, v208, vcc
  v_cndmask_b32 v210, v210, v209, s[68:69]
  v_accvgpr_write_b32 a211, v210
  v_accvgpr_write_b32 a212, 0
  v_accvgpr_write_b32 a213, 0
  v_accvgpr_write_b32 a214, 0
  v_accvgpr_write_b32 a215, 0
  v_bfe_u32 v208, v205, 1, 3
  v_xor_b32 v208, v208, v206
  v_lshlrev_b32 v209, 7, v205
  s_lshl_b32 s70, s12, 12
  v_add_u32 v209, s70, v209
  v_xor_b32 v210, 0, v208
  v_lshl_add_u32 v108, v210, 4, v209
  v_xor_b32 v210, 2, v208
  v_lshl_add_u32 v109, v210, 4, v209
  v_xor_b32 v210, 4, v208
  v_lshl_add_u32 v110, v210, 4, v209
  v_xor_b32 v210, 6, v208
  v_lshl_add_u32 v111, v210, 4, v209
  s_nop 15
  s_waitcnt lgkmcnt(0)
  s_barrier
  s_mov_b32 s40, s6
  s_mov_b32 s41, s7
  s_mov_b32 s42, 512
  s_mov_b32 s43, 0x20000
  v_lshrrev_b32 v205, 5, v115
  v_lshlrev_b32 v205, 3, v205
  s_lshl_b32 s70, s12, 7
  v_lshrrev_b32 v241, 2, v115
  v_xor_b32 v241, v241, v115
  v_bfe_u32 v241, v241, 2, 1
  v_lshl_add_u32 v205, v241, 12, v205
  buffer_load_dwordx2 v[240:241], v205, s[40:43], s70 offen offset:0
  buffer_load_dwordx2 v[242:243], v205, s[40:43], s70 offen offset:16
  buffer_load_dwordx2 v[244:245], v205, s[40:43], s70 offen offset:32
  buffer_load_dwordx2 v[246:247], v205, s[40:43], s70 offen offset:48
  buffer_load_dwordx2 v[248:249], v205, s[40:43], s70 offen offset:64
  buffer_load_dwordx2 v[250:251], v205, s[40:43], s70 offen offset:80
  buffer_load_dwordx2 v[252:253], v205, s[40:43], s70 offen offset:96
  buffer_load_dwordx2 v[254:255], v205, s[40:43], s70 offen offset:112
  ds_read_b128 v[96:99], v113 offset:256
  ds_read_b128 v[196:199], v113 offset:384
  v_mul_f32 v0, s78, v0
  v_mul_f32 v1, s78, v1
  v_mul_f32 v2, s78, v2
  v_mul_f32 v3, s78, v3
  v_mov_b32 v116, v232
  v_mov_b32 v117, v233
  v_cvt_pk_bf16_f32 v118, v0, v1
  v_cvt_pk_bf16_f32 v119, v2, v3
  s_nop 1
  v_permlane32_swap_b32 v116, v118
  v_permlane32_swap_b32 v117, v119
  v_mul_f32 v4, s78, v4
  v_mul_f32 v5, s78, v5
  v_mul_f32 v6, s78, v6
  v_mul_f32 v7, s78, v7
  v_mov_b32 v124, v232
  v_mov_b32 v125, v233
  v_cvt_pk_bf16_f32 v126, v4, v5
  v_cvt_pk_bf16_f32 v127, v6, v7
  s_nop 1
  v_permlane32_swap_b32 v124, v126
  v_permlane32_swap_b32 v125, v127
  v_mul_f32 v8, s78, v8
  v_mul_f32 v9, s78, v9
  v_mul_f32 v10, s78, v10
  v_mul_f32 v11, s78, v11
  v_mov_b32 v132, v232
  v_mov_b32 v133, v233
  v_cvt_pk_bf16_f32 v134, v8, v9
  v_cvt_pk_bf16_f32 v135, v10, v11
  s_nop 1
  v_permlane32_swap_b32 v132, v134
  v_permlane32_swap_b32 v133, v135
  v_mul_f32 v12, s78, v12
  v_mul_f32 v13, s78, v13
  v_mul_f32 v14, s78, v14
  v_mul_f32 v15, s78, v15
  v_mov_b32 v140, v232
  v_mov_b32 v141, v233
  v_cvt_pk_bf16_f32 v142, v12, v13
  v_cvt_pk_bf16_f32 v143, v14, v15
  s_nop 1
  v_permlane32_swap_b32 v140, v142
  v_permlane32_swap_b32 v141, v143
  v_mul_f32 v32, s78, v32
  v_mul_f32 v33, s78, v33
  v_mul_f32 v34, s78, v34
  v_mul_f32 v35, s78, v35
  v_mov_b32 v148, v232
  v_mov_b32 v149, v233
  v_cvt_pk_bf16_f32 v150, v32, v33
  v_cvt_pk_bf16_f32 v151, v34, v35
  s_nop 1
  v_permlane32_swap_b32 v148, v150
  v_permlane32_swap_b32 v149, v151
  v_mul_f32 v16, s78, v16
  v_mul_f32 v17, s78, v17
  v_mul_f32 v18, s78, v18
  v_mul_f32 v19, s78, v19
  v_mov_b32 v120, v234
  v_mov_b32 v121, v235
  v_cvt_pk_bf16_f32 v122, v16, v17
  v_cvt_pk_bf16_f32 v123, v18, v19
  s_nop 1
  v_permlane32_swap_b32 v120, v122
  v_permlane32_swap_b32 v121, v123
  v_mul_f32 v20, s78, v20
  v_mul_f32 v21, s78, v21
  v_mul_f32 v22, s78, v22
  v_mul_f32 v23, s78, v23
  v_mov_b32 v128, v234
  v_mov_b32 v129, v235
  v_cvt_pk_bf16_f32 v130, v20, v21
  v_cvt_pk_bf16_f32 v131, v22, v23
  s_nop 1
  v_permlane32_swap_b32 v128, v130
  v_permlane32_swap_b32 v129, v131
  v_mul_f32 v24, s78, v24
  v_mul_f32 v25, s78, v25
  v_mul_f32 v26, s78, v26
  v_mul_f32 v27, s78, v27
  v_mov_b32 v136, v234
  v_mov_b32 v137, v235
  v_cvt_pk_bf16_f32 v138, v24, v25
  v_cvt_pk_bf16_f32 v139, v26, v27
  s_nop 1
  v_permlane32_swap_b32 v136, v138
  v_permlane32_swap_b32 v137, v139
  v_mul_f32 v28, s78, v28
  v_mul_f32 v29, s78, v29
  v_mul_f32 v30, s78, v30
  v_mul_f32 v31, s78, v31
  v_mov_b32 v144, v234
  v_mov_b32 v145, v235
  v_cvt_pk_bf16_f32 v146, v28, v29
  v_cvt_pk_bf16_f32 v147, v30, v31
  s_nop 1
  v_permlane32_swap_b32 v144, v146
  v_permlane32_swap_b32 v145, v147
  v_mul_f32 v48, s78, v48
  v_mul_f32 v49, s78, v49
  v_mul_f32 v50, s78, v50
  v_mul_f32 v51, s78, v51
  v_mov_b32 v152, v234
  v_mov_b32 v153, v235
  v_cvt_pk_bf16_f32 v154, v48, v49
  v_cvt_pk_bf16_f32 v155, v50, v51
  s_nop 1
  v_permlane32_swap_b32 v152, v154
  v_permlane32_swap_b32 v153, v155
  s_waitcnt lgkmcnt(0)
  v_add_u32 v100, v96, v104
  v_add_u32 v101, v97, v105
  v_add_u32 v102, v98, v106
  v_add_u32 v103, v99, v107
  s_mov_b32 m0, s50
  s_nop 0
  buffer_load_dwordx4 v100, s[16:19], s52 offen offset:0 lds
  buffer_load_dwordx4 v101, s[16:19], s52 offen offset:1024 lds
  buffer_load_dwordx4 v102, s[16:19], s52 offen offset:2048 lds
  buffer_load_dwordx4 v103, s[16:19], s52 offen offset:3072 lds
  v_add_u32 v196, v196, v104
  v_add_u32 v197, v197, v105
  v_add_u32 v198, v198, v106
  v_add_u32 v199, v199, v107
  s_mov_b32 m0, s51
  s_nop 0
  buffer_load_dwordx4 v196, s[16:19], s52 offen offset:0 lds
  buffer_load_dwordx4 v197, s[16:19], s52 offen offset:1024 lds
  buffer_load_dwordx4 v198, s[16:19], s52 offen offset:2048 lds
  buffer_load_dwordx4 v199, s[16:19], s52 offen offset:3072 lds
  s_cmp_lg_u32 s76, 0
  s_cbranch_scc1 L_slow_start
  v_mov_b32 v48, 0
  v_accvgpr_write_b32 a196, 0
  v_mov_b32 v49, 0
  v_accvgpr_write_b32 a197, 0
  v_mov_b32 v50, 0
  v_accvgpr_write_b32 a198, 0
  v_mov_b32 v51, 0
  v_accvgpr_write_b32 a199, 0
  v_mov_b32 v52, 0
  v_accvgpr_write_b32 a200, 0
  v_mov_b32 v53, 0
  v_accvgpr_write_b32 a201, 0
  v_mov_b32 v54, 0
  v_accvgpr_write_b32 a202, 0
  v_mov_b32 v55, 0
  v_accvgpr_write_b32 a203, 0
  v_mfma_f32_32x32x16_bf16 v[64:79], a[212:215], a[212:215], 0
  v_mfma_f32_32x32x16_bf16 v[80:95], a[212:215], a[212:215], 0
  v_mov_b32 v56, v116
  v_mov_b32 v57, v117
  v_mov_b32 v58, v118
  v_mov_b32 v59, v119
  v_mov_b32 v60, v120
  v_mov_b32 v61, v121
  v_mov_b32 v62, v122
  v_mov_b32 v63, v123
  s_mov_b32 s54, 0
  s_mov_b32 s55, 0
  .p2align 3
L_fill:
  s_waitcnt vmcnt(12)
  ds_read_b128 a[176:179], v108 offset:0
  ds_read_b128 a[180:183], v109 offset:0
  ds_read_b128 a[192:195], v112
  s_waitcnt lgkmcnt(0)
  v_mfma_f32_32x32x16_bf16 v[0:15], a[176:179], a[204:207], 0
  v_mfma_f32_32x32x16_bf16 v[0:15], a[180:183], a[208:211], v[0:15]
  v_mfma_f32_32x32x16_bf16 v[0:15], a[192:195], v[56:59], v[0:15]
  ds_read_b128 v[96:99], v113 offset:512
  ds_read_b128 a[184:187], v110 offset:0
  ds_read_b128 a[188:191], v111 offset:0
  s_nop 15
  v_mfma_f32_32x32x16_bf16 v[80:95], v[48:51], a[196:199], v[80:95]
  s_nop 0
  s_waitcnt vmcnt(8)
  v_exp_f32 v32, v0
  v_exp_f32 v33, v1
  v_exp_f32 v34, v2
  v_mfma_f32_32x32x16_bf16 v[80:95], v[52:55], a[200:203], v[80:95]
  s_waitcnt lgkmcnt(0)
  ds_read_b128 a[176:179], v108 offset:16384
  v_exp_f32 v35, v3
  v_exp_f32 v36, v4
  v_exp_f32 v37, v5
  v_mfma_f32_32x32x16_bf16 v[16:31], a[184:187], a[204:207], 0
  s_mov_b32 s14, 10
  ds_read_b128 a[180:183], v109 offset:16384
  v_exp_f32 v38, v6
  v_exp_f32 v39, v7
  v_exp_f32 v40, v8
  v_mfma_f32_32x32x16_bf16 v[16:31], a[188:191], a[208:211], v[16:31]
  ds_read_b128 a[196:199], v112 offset:1024
  v_exp_f32 v41, v9
  v_exp_f32 v42, v10
  v_exp_f32_e64 v43, v11
  v_mfma_f32_32x32x16_bf16 v[16:31], a[192:195], v[60:63], v[16:31]
  ds_read_b128 a[200:203], v112 offset:2048
  ds_read_b128 a[192:195], v112 offset:3072
  s_add_u32 s15, s59, 131072
  buffer_load_dwordx4 a[0:3], v159, s[36:39], s15 offen offset:0
  buffer_load_dwordx4 a[4:7], v159, s[36:39], s15 offen offset:1024
  s_and_b32 s70, s53, 3
  v_exp_f32 v44, v12
  v_exp_f32 v45, v13
  v_exp_f32 v46, v14
  v_exp_f32_e64 v47, v15
  v_pk_add_f32 v[32:33], v[32:33], 1.0
  v_pk_add_f32 v[34:35], v[34:35], 1.0
  v_pk_add_f32 v[36:37], v[36:37], 1.0
  v_pk_add_f32 v[38:39], v[38:39], 1.0
  v_pk_add_f32 v[40:41], v[40:41], 1.0
  v_pk_add_f32 v[42:43], v[42:43], 1.0
  v_pk_add_f32 v[44:45], v[44:45], 1.0
  v_pk_add_f32 v[46:47], v[46:47], 1.0
  v_rcp_f32 v32, v32
  v_rcp_f32 v33, v33
  v_rcp_f32 v34, v34
  v_rcp_f32 v35, v35
  v_rcp_f32 v36, v36
  v_rcp_f32 v37, v37
  v_rcp_f32 v38, v38
  v_rcp_f32 v39, v39
  v_rcp_f32 v40, v40
  v_rcp_f32 v41, v41
  v_rcp_f32 v42, v42
  v_rcp_f32 v43, v43
  v_rcp_f32 v44, v44
  v_rcp_f32 v45, v45
  v_rcp_f32 v46, v46
  v_rcp_f32 v47, v47
  v_pk_mul_f32 v[32:33], v[32:33], v[0:1]
  v_pk_mul_f32 v[34:35], v[34:35], v[2:3]
  v_pk_mul_f32 v[36:37], v[36:37], v[4:5]
  v_pk_mul_f32 v[38:39], v[38:39], v[6:7]
  v_pk_mul_f32 v[40:41], v[40:41], v[8:9]
  v_pk_mul_f32 v[42:43], v[42:43], v[10:11]
  v_pk_mul_f32 v[44:45], v[44:45], v[12:13]
  v_pk_mul_f32 v[46:47], v[46:47], v[14:15]
  v_cvt_pk_bf16_f32 v48, v32, v33
  v_cvt_pk_bf16_f32 v49, v34, v35
  v_cvt_pk_bf16_f32 v50, v36, v37
  v_cvt_pk_bf16_f32 v51, v38, v39
  v_cvt_pk_bf16_f32 v52, v40, v41
  v_cvt_pk_bf16_f32 v53, v42, v43
  v_cvt_pk_bf16_f32 v54, v44, v45
  v_cvt_pk_bf16_f32 v55, v46, v47
  s_cbranch_scc0 L_ret10
  s_bitcmp1_b32 s53, 0
  s_cbranch_scc0 L_iy10
  s_set_gpr_idx_on s55, gpr_idx(DST)
  v_cvt_pk_bf16_f32 v160, v64, v65
  v_cvt_pk_bf16_f32 v161, v66, v67
  v_cvt_pk_bf16_f32 v162, v68, v69
  v_cvt_pk_bf16_f32 v163, v70, v71
  v_cvt_pk_bf16_f32 v164, v72, v73
  v_cvt_pk_bf16_f32 v165, v74, v75
  v_cvt_pk_bf16_f32 v166, v76, v77
  v_cvt_pk_bf16_f32 v167, v78, v79
  v_cvt_pk_bf16_f32 v168, v80, v81
  v_cvt_pk_bf16_f32 v169, v82, v83
  v_cvt_pk_bf16_f32 v170, v84, v85
  v_cvt_pk_bf16_f32 v171, v86, v87
  v_cvt_pk_bf16_f32 v172, v88, v89
  v_cvt_pk_bf16_f32 v173, v90, v91
  v_cvt_pk_bf16_f32 v174, v92, v93
  v_cvt_pk_bf16_f32 v175, v94, v95
  s_set_gpr_idx_off
  s_add_u32 s55, s55, 16
  s_cmp_lg_u32 s76, 0
  s_cbranch_scc1 L_h_slow
  v_mfma_f32_32x32x16_bf16 v[64:79], a[212:215], a[212:215], 0
  v_mfma_f32_32x32x16_bf16 v[80:95], a[212:215], a[212:215], 0
L_iy10:
  s_bitcmp1_b32 s53, 1
  s_cbranch_scc0 L_ret10
  s_add_u32 s54, s54, 8
  s_set_gpr_idx_on s54, gpr_idx(SRC0)
  v_mov_b32 v56, v116
  v_mov_b32 v57, v117
  v_mov_b32 v58, v118
  v_mov_b32 v59, v119
  v_mov_b32 v60, v120
  v_mov_b32 v61, v121
  v_mov_b32 v62, v122
  v_mov_b32 v63, v123
  s_set_gpr_idx_off
L_ret10:
  s_waitcnt lgkmcnt(0)
  v_mfma_f32_32x32x16_bf16 v[64:79], v[48:51], a[196:199], v[64:79]
  s_mov_b32 m0, s48
  v_exp_f32 v32, v16
  v_exp_f32 v33, v17
  v_exp_f32 v34, v18
  v_add_u32 v100, v96, v104
  v_add_u32 v101, v97, v105
  v_add_u32 v102, v98, v106
  v_add_u32 v103, v99, v107
  v_mfma_f32_32x32x16_bf16 v[64:79], v[52:55], a[200:203], v[64:79]
  s_lshr_b32 s53, s53, 1
  ds_read_b128 v[96:99], v113 offset:640
  v_exp_f32 v35, v19
  v_exp_f32 v36, v20
  v_exp_f32 v37, v21
  v_mfma_f32_32x32x16_bf16 v[0:15], a[176:179], a[204:207], 0
  ds_read_b128 a[184:187], v110 offset:16384
  v_exp_f32 v38, v22
  v_exp_f32 v39, v23
  v_exp_f32_e64 v40, v24
  v_mfma_f32_32x32x16_bf16 v[0:15], a[180:183], a[208:211], v[0:15]
  s_cmp_eq_u32 s53, 1
  ds_read_b128 a[188:191], v111 offset:16384
  v_exp_f32 v41, v25
  v_exp_f32 v42, v26
  v_exp_f32 v43, v27
  v_mfma_f32_32x32x16_bf16 v[0:15], a[192:195], v[56:59], v[0:15]
  s_add_u32 s15, s59, 131072
  buffer_load_dwordx4 a[8:11], v159, s[36:39], s15 offen offset:2048
  buffer_load_dwordx4 a[12:15], v159, s[36:39], s15 offen offset:3072
  buffer_load_dwordx4 v100, s[16:19], s52 offen offset:0 lds
  buffer_load_dwordx4 v101, s[16:19], s52 offen offset:1024 lds
  buffer_load_dwordx4 v102, s[16:19], s52 offen offset:2048 lds
  buffer_load_dwordx4 v103, s[16:19], s52 offen offset:3072 lds
  v_exp_f32 v44, v28
  v_exp_f32 v45, v29
  v_exp_f32 v46, v30
  v_exp_f32 v47, v31
  v_pk_add_f32 v[32:33], v[32:33], 1.0
  v_pk_add_f32 v[34:35], v[34:35], 1.0
  v_pk_add_f32 v[36:37], v[36:37], 1.0
  v_pk_add_f32 v[38:39], v[38:39], 1.0
  v_pk_add_f32 v[40:41], v[40:41], 1.0
  v_pk_add_f32 v[42:43], v[42:43], 1.0
  v_pk_add_f32 v[44:45], v[44:45], 1.0
  v_pk_add_f32 v[46:47], v[46:47], 1.0
  v_rcp_f32 v32, v32
  v_rcp_f32 v33, v33
  v_rcp_f32 v34, v34
  v_rcp_f32 v35, v35
  v_rcp_f32 v36, v36
  v_rcp_f32 v37, v37
  v_rcp_f32 v38, v38
  v_rcp_f32 v39, v39
  v_rcp_f32 v40, v40
  v_rcp_f32 v41, v41
  v_rcp_f32 v42, v42
  v_rcp_f32 v43, v43
  v_rcp_f32 v44, v44
  v_rcp_f32 v45, v45
  v_rcp_f32 v46, v46
  v_rcp_f32 v47, v47
  v_pk_mul_f32 v[32:33], v[32:33], v[16:17]
  v_pk_mul_f32 v[34:35], v[34:35], v[18:19]
  v_pk_mul_f32 v[36:37], v[36:37], v[20:21]
  v_pk_mul_f32 v[38:39], v[38:39], v[22:23]
  v_pk_mul_f32 v[40:41], v[40:41], v[24:25]
  v_pk_mul_f32 v[42:43], v[42:43], v[26:27]
  v_pk_mul_f32 v[44:45], v[44:45], v[28:29]
  v_pk_mul_f32 v[46:47], v[46:47], v[30:31]
  v_cvt_pk_bf16_f32 v48, v32, v33
  v_cvt_pk_bf16_f32 v49, v34, v35
  v_cvt_pk_bf16_f32 v50, v36, v37
  v_cvt_pk_bf16_f32 v51, v38, v39
  v_cvt_pk_bf16_f32 v52, v40, v41
  v_cvt_pk_bf16_f32 v53, v42, v43
  v_cvt_pk_bf16_f32 v54, v44, v45
  v_cvt_pk_bf16_f32 v55, v46, v47
  v_mfma_f32_32x32x16_bf16 v[80:95], v[48:51], a[196:199], v[80:95]
  s_nop 0
  s_waitcnt vmcnt(12)
  v_exp_f32 v32, v0
  v_exp_f32 v33, v1
  v_exp_f32_e64 v34, v2
  v_mfma_f32_32x32x16_bf16 v[80:95], v[52:55], a[200:203], v[80:95]
  s_waitcnt lgkmcnt(0)
  ds_read_b128 a[176:179], v108 offset:32768
  v_exp_f32 v35, v3
  v_exp_f32 v36, v4
  v_exp_f32 v37, v5
  v_mfma_f32_32x32x16_bf16 v[16:31], a[184:187], a[204:207], 0
  s_mov_b32 s14, 11
  ds_read_b128 a[180:183], v109 offset:32768
  v_exp_f32 v38, v6
  v_exp_f32 v39, v7
  v_exp_f32 v40, v8
  v_mfma_f32_32x32x16_bf16 v[16:31], a[188:191], a[208:211], v[16:31]
  ds_read_b128 a[196:199], v112 offset:4096
  v_exp_f32 v41, v9
  v_exp_f32 v42, v10
  v_exp_f32_e64 v43, v11
  v_mfma_f32_32x32x16_bf16 v[16:31], a[192:195], v[60:63], v[16:31]
  ds_read_b128 a[200:203], v112 offset:5120
  ds_read_b128 a[192:195], v112 offset:6144
  s_add_u32 s15, s59, 135168
  buffer_load_dwordx4 a[16:19], v159, s[36:39], s15 offen offset:0
  buffer_load_dwordx4 a[20:23], v159, s[36:39], s15 offen offset:1024
  buffer_load_dwordx4 a[24:27], v159, s[36:39], s15 offen offset:2048
  buffer_load_dwordx4 a[28:31], v159, s[36:39], s15 offen offset:3072
  s_and_b32 s70, s53, 3
  v_exp_f32 v44, v12
  v_exp_f32 v45, v13
  v_exp_f32 v46, v14
  v_exp_f32_e64 v47, v15
  v_pk_add_f32 v[32:33], v[32:33], 1.0
  v_pk_add_f32 v[34:35], v[34:35], 1.0
  v_pk_add_f32 v[36:37], v[36:37], 1.0
  v_pk_add_f32 v[38:39], v[38:39], 1.0
  v_pk_add_f32 v[40:41], v[40:41], 1.0
  v_pk_add_f32 v[42:43], v[42:43], 1.0
  v_pk_add_f32 v[44:45], v[44:45], 1.0
  v_pk_add_f32 v[46:47], v[46:47], 1.0
  v_rcp_f32 v32, v32
  v_rcp_f32 v33, v33
  v_rcp_f32 v34, v34
  v_rcp_f32 v35, v35
  v_rcp_f32 v36, v36
  v_rcp_f32 v37, v37
  v_rcp_f32 v38, v38
  v_rcp_f32 v39, v39
  v_rcp_f32 v40, v40
  v_rcp_f32 v41, v41
  v_rcp_f32 v42, v42
  v_rcp_f32 v43, v43
  v_rcp_f32 v44, v44
  v_rcp_f32 v45, v45
  v_rcp_f32 v46, v46
  v_rcp_f32 v47, v47
  v_pk_mul_f32 v[32:33], v[32:33], v[0:1]
  v_pk_mul_f32 v[34:35], v[34:35], v[2:3]
  v_pk_mul_f32 v[36:37], v[36:37], v[4:5]
  v_pk_mul_f32 v[38:39], v[38:39], v[6:7]
  v_pk_mul_f32 v[40:41], v[40:41], v[8:9]
  v_pk_mul_f32 v[42:43], v[42:43], v[10:11]
  v_pk_mul_f32 v[44:45], v[44:45], v[12:13]
  v_pk_mul_f32 v[46:47], v[46:47], v[14:15]
  v_cvt_pk_bf16_f32 v48, v32, v33
  v_cvt_pk_bf16_f32 v49, v34, v35
  v_cvt_pk_bf16_f32 v50, v36, v37
  v_cvt_pk_bf16_f32 v51, v38, v39
  v_cvt_pk_bf16_f32 v52, v40, v41
  v_cvt_pk_bf16_f32 v53, v42, v43
  v_cvt_pk_bf16_f32 v54, v44, v45
  v_cvt_pk_bf16_f32 v55, v46, v47
  s_cbranch_scc0 L_ret11
  s_bitcmp1_b32 s53, 0
  s_cbranch_scc0 L_iy11
  s_set_gpr_idx_on s55, gpr_idx(DST)
  v_cvt_pk_bf16_f32 v160, v64, v65
  v_cvt_pk_bf16_f32 v161, v66, v67
  v_cvt_pk_bf16_f32 v162, v68, v69
  v_cvt_pk_bf16_f32 v163, v70, v71
  v_cvt_pk_bf16_f32 v164, v72, v73
  v_cvt_pk_bf16_f32 v165, v74, v75
  v_cvt_pk_bf16_f32 v166, v76, v77
  v_cvt_pk_bf16_f32 v167, v78, v79
  v_cvt_pk_bf16_f32 v168, v80, v81
  v_cvt_pk_bf16_f32 v169, v82, v83
  v_cvt_pk_bf16_f32 v170, v84, v85
  v_cvt_pk_bf16_f32 v171, v86, v87
  v_cvt_pk_bf16_f32 v172, v88, v89
  v_cvt_pk_bf16_f32 v173, v90, v91
  v_cvt_pk_bf16_f32 v174, v92, v93
  v_cvt_pk_bf16_f32 v175, v94, v95
  s_set_gpr_idx_off
  s_add_u32 s55, s55, 16
  s_cmp_lg_u32 s76, 0
  s_cbranch_scc1 L_h_slow
  v_mfma_f32_32x32x16_bf16 v[64:79], a[212:215], a[212:215], 0
  v_mfma_f32_32x32x16_bf16 v[80:95], a[212:215], a[212:215], 0
L_iy11:
  s_bitcmp1_b32 s53, 1
  s_cbranch_scc0 L_ret11
  s_add_u32 s54, s54, 8
  s_set_gpr_idx_on s54, gpr_idx(SRC0)
  v_mov_b32 v56, v116
  v_mov_b32 v57, v117
  v_mov_b32 v58, v118
  v_mov_b32 v59, v119
  v_mov_b32 v60, v120
  v_mov_b32 v61, v121
  v_mov_b32 v62, v122
  v_mov_b32 v63, v123
  s_set_gpr_idx_off
L_ret11:
  s_waitcnt lgkmcnt(0)
  v_mfma_f32_32x32x16_bf16 v[64:79], v[48:51], a[196:199], v[64:79]
  s_mov_b32 m0, s49
  v_exp_f32 v32, v16
  v_exp_f32 v33, v17
  v_exp_f32 v34, v18
  v_add_u32 v100, v96, v104
  v_add_u32 v101, v97, v105
  v_add_u32 v102, v98, v106
  v_add_u32 v103, v99, v107
  v_mfma_f32_32x32x16_bf16 v[64:79], v[52:55], a[200:203], v[64:79]
  s_lshr_b32 s53, s53, 1
  ds_read_b128 v[96:99], v113 offset:768
  v_exp_f32 v35, v19
  v_exp_f32 v36, v20
  v_exp_f32 v37, v21
  v_mfma_f32_32x32x16_bf16 v[0:15], a[176:179], a[204:207], 0
  ds_read_b128 a[184:187], v110 offset:32768
  v_exp_f32 v38, v22
  v_exp_f32 v39, v23
  v_exp_f32_e64 v40, v24
  v_mfma_f32_32x32x16_bf16 v[0:15], a[180:183], a[208:211], v[0:15]
  s_cmp_eq_u32 s53, 1
  ds_read_b128 a[188:191], v111 offset:32768
  v_exp_f32 v41, v25
  v_exp_f32 v42, v26
  v_exp_f32 v43, v27
  v_mfma_f32_32x32x16_bf16 v[0:15], a[192:195], v[56:59], v[0:15]
  s_add_u32 s15, s59, 139264
  buffer_load_dwordx4 a[32:35], v159, s[36:39], s15 offen offset:0
  buffer_load_dwordx4 a[36:39], v159, s[36:39], s15 offen offset:1024
  buffer_load_dwordx4 a[40:43], v159, s[36:39], s15 offen offset:2048
  buffer_load_dwordx4 v100, s[16:19], s52 offen offset:0 lds
  buffer_load_dwordx4 v101, s[16:19], s52 offen offset:1024 lds
  buffer_load_dwordx4 v102, s[16:19], s52 offen offset:2048 lds
  buffer_load_dwordx4 v103, s[16:19], s52 offen offset:3072 lds
  v_exp_f32 v44, v28
  v_exp_f32 v45, v29
  v_exp_f32 v46, v30
  v_exp_f32 v47, v31
  v_pk_add_f32 v[32:33], v[32:33], 1.0
  v_pk_add_f32 v[34:35], v[34:35], 1.0
  v_pk_add_f32 v[36:37], v[36:37], 1.0
  v_pk_add_f32 v[38:39], v[38:39], 1.0
  v_pk_add_f32 v[40:41], v[40:41], 1.0
  v_pk_add_f32 v[42:43], v[42:43], 1.0
  v_pk_add_f32 v[44:45], v[44:45], 1.0
  v_pk_add_f32 v[46:47], v[46:47], 1.0
  v_rcp_f32 v32, v32
  v_rcp_f32 v33, v33
  v_rcp_f32 v34, v34
  v_rcp_f32 v35, v35
  v_rcp_f32 v36, v36
  v_rcp_f32 v37, v37
  v_rcp_f32 v38, v38
  v_rcp_f32 v39, v39
  v_rcp_f32 v40, v40
  v_rcp_f32 v41, v41
  v_rcp_f32 v42, v42
  v_rcp_f32 v43, v43
  v_rcp_f32 v44, v44
  v_rcp_f32 v45, v45
  v_rcp_f32 v46, v46
  v_rcp_f32 v47, v47
  v_pk_mul_f32 v[32:33], v[32:33], v[16:17]
  v_pk_mul_f32 v[34:35], v[34:35], v[18:19]
  v_pk_mul_f32 v[36:37], v[36:37], v[20:21]
  v_pk_mul_f32 v[38:39], v[38:39], v[22:23]
  v_pk_mul_f32 v[40:41], v[40:41], v[24:25]
  v_pk_mul_f32 v[42:43], v[42:43], v[26:27]
  v_pk_mul_f32 v[44:45], v[44:45], v[28:29]
  v_pk_mul_f32 v[46:47], v[46:47], v[30:31]
  v_cvt_pk_bf16_f32 v48, v32, v33
  v_cvt_pk_bf16_f32 v49, v34, v35
  v_cvt_pk_bf16_f32 v50, v36, v37
  v_cvt_pk_bf16_f32 v51, v38, v39
  v_cvt_pk_bf16_f32 v52, v40, v41
  v_cvt_pk_bf16_f32 v53, v42, v43
  v_cvt_pk_bf16_f32 v54, v44, v45
  v_cvt_pk_bf16_f32 v55, v46, v47
  v_mfma_f32_32x32x16_bf16 v[80:95], v[48:51], a[196:199], v[80:95]
  s_nop 0
  s_waitcnt vmcnt(19)
  v_exp_f32 v32, v0
  v_exp_f32 v33, v1
  v_exp_f32_e64 v34, v2
  v_mfma_f32_32x32x16_bf16 v[80:95], v[52:55], a[200:203], v[80:95]
  s_waitcnt lgkmcnt(0)
  ds_read_b128 a[176:179], v108 offset:49152
  v_exp_f32 v35, v3
  v_exp_f32 v36, v4
  v_exp_f32 v37, v5
  v_mfma_f32_32x32x16_bf16 v[16:31], a[184:187], a[204:207], 0
  s_mov_b32 s14, 12
  ds_read_b128 a[180:183], v109 offset:49152
  v_exp_f32 v38, v6
  v_exp_f32 v39, v7
  v_exp_f32 v40, v8
  v_mfma_f32_32x32x16_bf16 v[16:31], a[188:191], a[208:211], v[16:31]
  ds_read_b128 a[196:199], v112 offset:7168
  v_exp_f32 v41, v9
  v_exp_f32 v42, v10
  v_exp_f32_e64 v43, v11
  v_mfma_f32_32x32x16_bf16 v[16:31], a[192:195], v[60:63], v[16:31]
  ds_read_b128 a[200:203], v112 offset:8192
  ds_read_b128 a[192:195], v112 offset:9216
  s_add_u32 s15, s59, 139264
  buffer_load_dwordx4 a[44:47], v159, s[36:39], s15 offen offset:3072
  s_add_u32 s15, s59, 143360
  buffer_load_dwordx4 a[48:51], v159, s[36:39], s15 offen offset:0
  buffer_load_dwordx4 a[52:55], v159, s[36:39], s15 offen offset:1024
  buffer_load_dwordx4 a[56:59], v159, s[36:39], s15 offen offset:2048
  s_and_b32 s70, s53, 3
  v_exp_f32 v44, v12
  v_exp_f32 v45, v13
  v_exp_f32 v46, v14
  v_exp_f32_e64 v47, v15
  v_pk_add_f32 v[32:33], v[32:33], 1.0
  v_pk_add_f32 v[34:35], v[34:35], 1.0
  v_pk_add_f32 v[36:37], v[36:37], 1.0
  v_pk_add_f32 v[38:39], v[38:39], 1.0
  v_pk_add_f32 v[40:41], v[40:41], 1.0
  v_pk_add_f32 v[42:43], v[42:43], 1.0
  v_pk_add_f32 v[44:45], v[44:45], 1.0
  v_pk_add_f32 v[46:47], v[46:47], 1.0
  v_rcp_f32 v32, v32
  v_rcp_f32 v33, v33
  v_rcp_f32 v34, v34
  v_rcp_f32 v35, v35
  v_rcp_f32 v36, v36
  v_rcp_f32 v37, v37
  v_rcp_f32 v38, v38
  v_rcp_f32 v39, v39
  v_rcp_f32 v40, v40
  v_rcp_f32 v41, v41
  v_rcp_f32 v42, v42
  v_rcp_f32 v43, v43
  v_rcp_f32 v44, v44
  v_rcp_f32 v45, v45
  v_rcp_f32 v46, v46
  v_rcp_f32 v47, v47
  v_pk_mul_f32 v[32:33], v[32:33], v[0:1]
  v_pk_mul_f32 v[34:35], v[34:35], v[2:3]
  v_pk_mul_f32 v[36:37], v[36:37], v[4:5]
  v_pk_mul_f32 v[38:39], v[38:39], v[6:7]
  v_pk_mul_f32 v[40:41], v[40:41], v[8:9]
  v_pk_mul_f32 v[42:43], v[42:43], v[10:11]
  v_pk_mul_f32 v[44:45], v[44:45], v[12:13]
  v_pk_mul_f32 v[46:47], v[46:47], v[14:15]
  v_cvt_pk_bf16_f32 v48, v32, v33
  v_cvt_pk_bf16_f32 v49, v34, v35
  v_cvt_pk_bf16_f32 v50, v36, v37
  v_cvt_pk_bf16_f32 v51, v38, v39
  v_cvt_pk_bf16_f32 v52, v40, v41
  v_cvt_pk_bf16_f32 v53, v42, v43
  v_cvt_pk_bf16_f32 v54, v44, v45
  v_cvt_pk_bf16_f32 v55, v46, v47
  s_cbranch_scc0 L_ret12
  s_bitcmp1_b32 s53, 0
  s_cbranch_scc0 L_iy12
  s_set_gpr_idx_on s55, gpr_idx(DST)
  v_cvt_pk_bf16_f32 v160, v64, v65
  v_cvt_pk_bf16_f32 v161, v66, v67
  v_cvt_pk_bf16_f32 v162, v68, v69
  v_cvt_pk_bf16_f32 v163, v70, v71
  v_cvt_pk_bf16_f32 v164, v72, v73
  v_cvt_pk_bf16_f32 v165, v74, v75
  v_cvt_pk_bf16_f32 v166, v76, v77
  v_cvt_pk_bf16_f32 v167, v78, v79
  v_cvt_pk_bf16_f32 v168, v80, v81
  v_cvt_pk_bf16_f32 v169, v82, v83
  v_cvt_pk_bf16_f32 v170, v84, v85
  v_cvt_pk_bf16_f32 v171, v86, v87
  v_cvt_pk_bf16_f32 v172, v88, v89
  v_cvt_pk_bf16_f32 v173, v90, v91
  v_cvt_pk_bf16_f32 v174, v92, v93
  v_cvt_pk_bf16_f32 v175, v94, v95
  s_set_gpr_idx_off
  s_add_u32 s55, s55, 16
  s_cmp_lg_u32 s76, 0
  s_cbranch_scc1 L_h_slow
  v_mfma_f32_32x32x16_bf16 v[64:79], a[212:215], a[212:215], 0
  v_mfma_f32_32x32x16_bf16 v[80:95], a[212:215], a[212:215], 0
L_iy12:
  s_bitcmp1_b32 s53, 1
  s_cbranch_scc0 L_ret12
  s_add_u32 s54, s54, 8
  s_set_gpr_idx_on s54, gpr_idx(SRC0)
  v_mov_b32 v56, v116
  v_mov_b32 v57, v117
  v_mov_b32 v58, v118
  v_mov_b32 v59, v119
  v_mov_b32 v60, v120
  v_mov_b32 v61, v121
  v_mov_b32 v62, v122
  v_mov_b32 v63, v123
  s_set_gpr_idx_off
L_ret12:
  s_waitcnt lgkmcnt(0)
  v_mfma_f32_32x32x16_bf16 v[64:79], v[48:51], a[196:199], v[64:79]
  s_mov_b32 m0, s50
  v_exp_f32 v32, v16
  v_exp_f32 v33, v17
  v_exp_f32 v34, v18
  v_add_u32 v100, v96, v104
  v_add_u32 v101, v97, v105
  v_add_u32 v102, v98, v106
  v_add_u32 v103, v99, v107
  v_mfma_f32_32x32x16_bf16 v[64:79], v[52:55], a[200:203], v[64:79]
  s_lshr_b32 s53, s53, 1
  ds_read_b128 v[96:99], v113 offset:896
  v_exp_f32 v35, v19
  v_exp_f32 v36, v20
  v_exp_f32 v37, v21
  v_mfma_f32_32x32x16_bf16 v[0:15], a[176:179], a[204:207], 0
  ds_read_b128 a[184:187], v110 offset:49152
  v_exp_f32 v38, v22
  v_exp_f32 v39, v23
  v_exp_f32_e64 v40, v24
  v_mfma_f32_32x32x16_bf16 v[0:15], a[180:183], a[208:211], v[0:15]
  s_cmp_eq_u32 s53, 1
  ds_read_b128 a[188:191], v111 offset:49152
  v_exp_f32 v41, v25
  v_exp_f32 v42, v26
  v_exp_f32 v43, v27
  v_mfma_f32_32x32x16_bf16 v[0:15], a[192:195], v[56:59], v[0:15]
  s_add_u32 s15, s59, 143360
  buffer_load_dwordx4 a[60:63], v159, s[36:39], s15 offen offset:3072
  s_add_u32 s15, s59, 147456
  buffer_load_dwordx4 a[64:67], v159, s[36:39], s15 offen offset:0
  buffer_load_dwordx4 a[68:71], v159, s[36:39], s15 offen offset:1024
  buffer_load_dwordx4 v100, s[16:19], s52 offen offset:0 lds
  buffer_load_dwordx4 v101, s[16:19], s52 offen offset:1024 lds
  buffer_load_dwordx4 v102, s[16:19], s52 offen offset:2048 lds
  buffer_load_dwordx4 v103, s[16:19], s52 offen offset:3072 lds
  v_exp_f32 v44, v28
  v_exp_f32 v45, v29
  v_exp_f32 v46, v30
  v_exp_f32 v47, v31
  v_pk_add_f32 v[32:33], v[32:33], 1.0
  v_pk_add_f32 v[34:35], v[34:35], 1.0
  v_pk_add_f32 v[36:37], v[36:37], 1.0
  v_pk_add_f32 v[38:39], v[38:39], 1.0
  v_pk_add_f32 v[40:41], v[40:41], 1.0
  v_pk_add_f32 v[42:43], v[42:43], 1.0
  v_pk_add_f32 v[44:45], v[44:45], 1.0
  v_pk_add_f32 v[46:47], v[46:47], 1.0
  v_rcp_f32 v32, v32
  v_rcp_f32 v33, v33
  v_rcp_f32 v34, v34
  v_rcp_f32 v35, v35
  v_rcp_f32 v36, v36
  v_rcp_f32 v37, v37
  v_rcp_f32 v38, v38
  v_rcp_f32 v39, v39
  v_rcp_f32 v40, v40
  v_rcp_f32 v41, v41
  v_rcp_f32 v42, v42
  v_rcp_f32 v43, v43
  v_rcp_f32 v44, v44
  v_rcp_f32 v45, v45
  v_rcp_f32 v46, v46
  v_rcp_f32 v47, v47
  v_pk_mul_f32 v[32:33], v[32:33], v[16:17]
  v_pk_mul_f32 v[34:35], v[34:35], v[18:19]
  v_pk_mul_f32 v[36:37], v[36:37], v[20:21]
  v_pk_mul_f32 v[38:39], v[38:39], v[22:23]
  v_pk_mul_f32 v[40:41], v[40:41], v[24:25]
  v_pk_mul_f32 v[42:43], v[42:43], v[26:27]
  v_pk_mul_f32 v[44:45], v[44:45], v[28:29]
  v_pk_mul_f32 v[46:47], v[46:47], v[30:31]
  v_cvt_pk_bf16_f32 v48, v32, v33
  v_cvt_pk_bf16_f32 v49, v34, v35
  v_cvt_pk_bf16_f32 v50, v36, v37
  v_cvt_pk_bf16_f32 v51, v38, v39
  v_cvt_pk_bf16_f32 v52, v40, v41
  v_cvt_pk_bf16_f32 v53, v42, v43
  v_cvt_pk_bf16_f32 v54, v44, v45
  v_cvt_pk_bf16_f32 v55, v46, v47
  v_mfma_f32_32x32x16_bf16 v[80:95], v[48:51], a[196:199], v[80:95]
  s_nop 0
  s_waitcnt vmcnt(22)
  v_exp_f32 v32, v0
  v_exp_f32 v33, v1
  v_exp_f32_e64 v34, v2
  v_mfma_f32_32x32x16_bf16 v[80:95], v[52:55], a[200:203], v[80:95]
  s_waitcnt lgkmcnt(0)
  ds_read_b128 a[176:179], v108 offset:0
  v_exp_f32 v35, v3
  v_exp_f32 v36, v4
  v_exp_f32 v37, v5
  v_mfma_f32_32x32x16_bf16 v[16:31], a[184:187], a[204:207], 0
  s_mov_b32 s14, 13
  ds_read_b128 a[180:183], v109 offset:0
  v_exp_f32 v38, v6
  v_exp_f32 v39, v7
  v_exp_f32 v40, v8
  v_mfma_f32_32x32x16_bf16 v[16:31], a[188:191], a[208:211], v[16:31]
  ds_read_b128 a[196:199], v112 offset:10240
  v_exp_f32 v41, v9
  v_exp_f32 v42, v10
  v_exp_f32_e64 v43, v11
  v_mfma_f32_32x32x16_bf16 v[16:31], a[192:195], v[60:63], v[16:31]
  ds_read_b128 a[200:203], v112 offset:11264
  ds_read_b128 a[192:195], v112 offset:12288
  s_add_u32 s15, s59, 147456
  buffer_load_dwordx4 a[72:75], v159, s[36:39], s15 offen offset:2048
  buffer_load_dwordx4 a[76:79], v159, s[36:39], s15 offen offset:3072
  s_add_u32 s15, s59, 151552
  buffer_load_dwordx4 a[80:83], v159, s[36:39], s15 offen offset:0
  buffer_load_dwordx4 a[84:87], v159, s[36:39], s15 offen offset:1024
  s_and_b32 s70, s53, 3
  v_exp_f32 v44, v12
  v_exp_f32 v45, v13
  v_exp_f32 v46, v14
  v_exp_f32_e64 v47, v15
  v_pk_add_f32 v[32:33], v[32:33], 1.0
  v_pk_add_f32 v[34:35], v[34:35], 1.0
  v_pk_add_f32 v[36:37], v[36:37], 1.0
  v_pk_add_f32 v[38:39], v[38:39], 1.0
  v_pk_add_f32 v[40:41], v[40:41], 1.0
  v_pk_add_f32 v[42:43], v[42:43], 1.0
  v_pk_add_f32 v[44:45], v[44:45], 1.0
  v_pk_add_f32 v[46:47], v[46:47], 1.0
  v_rcp_f32 v32, v32
  v_rcp_f32 v33, v33
  v_rcp_f32 v34, v34
  v_rcp_f32 v35, v35
  v_rcp_f32 v36, v36
  v_rcp_f32 v37, v37
  v_rcp_f32 v38, v38
  v_rcp_f32 v39, v39
  v_rcp_f32 v40, v40
  v_rcp_f32 v41, v41
  v_rcp_f32 v42, v42
  v_rcp_f32 v43, v43
  v_rcp_f32 v44, v44
  v_rcp_f32 v45, v45
  v_rcp_f32 v46, v46
  v_rcp_f32 v47, v47
  v_pk_mul_f32 v[32:33], v[32:33], v[0:1]
  v_pk_mul_f32 v[34:35], v[34:35], v[2:3]
  v_pk_mul_f32 v[36:37], v[36:37], v[4:5]
  v_pk_mul_f32 v[38:39], v[38:39], v[6:7]
  v_pk_mul_f32 v[40:41], v[40:41], v[8:9]
  v_pk_mul_f32 v[42:43], v[42:43], v[10:11]
  v_pk_mul_f32 v[44:45], v[44:45], v[12:13]
  v_pk_mul_f32 v[46:47], v[46:47], v[14:15]
  v_cvt_pk_bf16_f32 v48, v32, v33
  v_cvt_pk_bf16_f32 v49, v34, v35
  v_cvt_pk_bf16_f32 v50, v36, v37
  v_cvt_pk_bf16_f32 v51, v38, v39
  v_cvt_pk_bf16_f32 v52, v40, v41
  v_cvt_pk_bf16_f32 v53, v42, v43
  v_cvt_pk_bf16_f32 v54, v44, v45
  v_cvt_pk_bf16_f32 v55, v46, v47
  s_cbranch_scc0 L_ret13
  s_bitcmp1_b32 s53, 0
  s_cbranch_scc0 L_iy13
  s_set_gpr_idx_on s55, gpr_idx(DST)
  v_cvt_pk_bf16_f32 v160, v64, v65
  v_cvt_pk_bf16_f32 v161, v66, v67
  v_cvt_pk_bf16_f32 v162, v68, v69
  v_cvt_pk_bf16_f32 v163, v70, v71
  v_cvt_pk_bf16_f32 v164, v72, v73
  v_cvt_pk_bf16_f32 v165, v74, v75
  v_cvt_pk_bf16_f32 v166, v76, v77
  v_cvt_pk_bf16_f32 v167, v78, v79
  v_cvt_pk_bf16_f32 v168, v80, v81
  v_cvt_pk_bf16_f32 v169, v82, v83
  v_cvt_pk_bf16_f32 v170, v84, v85
  v_cvt_pk_bf16_f32 v171, v86, v87
  v_cvt_pk_bf16_f32 v172, v88, v89
  v_cvt_pk_bf16_f32 v173, v90, v91
  v_cvt_pk_bf16_f32 v174, v92, v93
  v_cvt_pk_bf16_f32 v175, v94, v95
  s_set_gpr_idx_off
  s_add_u32 s55, s55, 16
  s_cmp_lg_u32 s76, 0
  s_cbranch_scc1 L_h_slow
  v_mfma_f32_32x32x16_bf16 v[64:79], a[212:215], a[212:215], 0
  v_mfma_f32_32x32x16_bf16 v[80:95], a[212:215], a[212:215], 0
L_iy13:
  s_bitcmp1_b32 s53, 1
  s_cbranch_scc0 L_ret13
  s_add_u32 s54, s54, 8
  s_set_gpr_idx_on s54, gpr_idx(SRC0)
  v_mov_b32 v56, v116
  v_mov_b32 v57, v117
  v_mov_b32 v58, v118
  v_mov_b32 v59, v119
  v_mov_b32 v60, v120
  v_mov_b32 v61, v121
  v_mov_b32 v62, v122
  v_mov_b32 v63, v123
  s_set_gpr_idx_off
L_ret13:
  s_waitcnt lgkmcnt(0)
  v_mfma_f32_32x32x16_bf16 v[64:79], v[48:51], a[196:199], v[64:79]
  s_mov_b32 m0, s51
  v_exp_f32 v32, v16
  v_exp_f32 v33, v17
  v_exp_f32 v34, v18
  v_add_u32 v100, v96, v104
  v_add_u32 v101, v97, v105
  v_add_u32 v102, v98, v106
  v_add_u32 v103, v99, v107
  v_mfma_f32_32x32x16_bf16 v[64:79], v[52:55], a[200:203], v[64:79]
  s_lshr_b32 s53, s53, 1
  ds_read_b128 v[96:99], v113 offset:1024
  v_exp_f32 v35, v19
  v_exp_f32 v36, v20
  v_exp_f32 v37, v21
  v_mfma_f32_32x32x16_bf16 v[0:15], a[176:179], a[204:207], 0
  ds_read_b128 a[184:187], v110 offset:0
  v_exp_f32 v38, v22
  v_exp_f32 v39, v23
  v_exp_f32_e64 v40, v24
  v_mfma_f32_32x32x16_bf16 v[0:15], a[180:183], a[208:211], v[0:15]
  s_cmp_eq_u32 s53, 1
  ds_read_b128 a[188:191], v111 offset:0
  v_exp_f32 v41, v25
  v_exp_f32 v42, v26
  v_exp_f32 v43, v27
  v_mfma_f32_32x32x16_bf16 v[0:15], a[192:195], v[56:59], v[0:15]
  s_add_u32 s15, s59, 151552
  buffer_load_dwordx4 a[88:91], v159, s[36:39], s15 offen offset:2048
  buffer_load_dwordx4 a[92:95], v159, s[36:39], s15 offen offset:3072
  s_add_u32 s15, s59, 155648
  buffer_load_dwordx4 a[96:99], v159, s[36:39], s15 offen offset:0
  buffer_load_dwordx4 v100, s[16:19], s52 offen offset:0 lds
  buffer_load_dwordx4 v101, s[16:19], s52 offen offset:1024 lds
  buffer_load_dwordx4 v102, s[16:19], s52 offen offset:2048 lds
  buffer_load_dwordx4 v103, s[16:19], s52 offen offset:3072 lds
  v_exp_f32 v44, v28
  v_exp_f32 v45, v29
  v_exp_f32 v46, v30
  v_exp_f32 v47, v31
  v_pk_add_f32 v[32:33], v[32:33], 1.0
  v_pk_add_f32 v[34:35], v[34:35], 1.0
  v_pk_add_f32 v[36:37], v[36:37], 1.0
  v_pk_add_f32 v[38:39], v[38:39], 1.0
  v_pk_add_f32 v[40:41], v[40:41], 1.0
  v_pk_add_f32 v[42:43], v[42:43], 1.0
  v_pk_add_f32 v[44:45], v[44:45], 1.0
  v_pk_add_f32 v[46:47], v[46:47], 1.0
  v_rcp_f32 v32, v32
  v_rcp_f32 v33, v33
  v_rcp_f32 v34, v34
  v_rcp_f32 v35, v35
  v_rcp_f32 v36, v36
  v_rcp_f32 v37, v37
  v_rcp_f32 v38, v38
  v_rcp_f32 v39, v39
  v_rcp_f32 v40, v40
  v_rcp_f32 v41, v41
  v_rcp_f32 v42, v42
  v_rcp_f32 v43, v43
  v_rcp_f32 v44, v44
  v_rcp_f32 v45, v45
  v_rcp_f32 v46, v46
  v_rcp_f32 v47, v47
  v_pk_mul_f32 v[32:33], v[32:33], v[16:17]
  v_pk_mul_f32 v[34:35], v[34:35], v[18:19]
  v_pk_mul_f32 v[36:37], v[36:37], v[20:21]
  v_pk_mul_f32 v[38:39], v[38:39], v[22:23]
  v_pk_mul_f32 v[40:41], v[40:41], v[24:25]
  v_pk_mul_f32 v[42:43], v[42:43], v[26:27]
  v_pk_mul_f32 v[44:45], v[44:45], v[28:29]
  v_pk_mul_f32 v[46:47], v[46:47], v[30:31]
  v_cvt_pk_bf16_f32 v48, v32, v33
  v_cvt_pk_bf16_f32 v49, v34, v35
  v_cvt_pk_bf16_f32 v50, v36, v37
  v_cvt_pk_bf16_f32 v51, v38, v39
  v_cvt_pk_bf16_f32 v52, v40, v41
  v_cvt_pk_bf16_f32 v53, v42, v43
  v_cvt_pk_bf16_f32 v54, v44, v45
  v_cvt_pk_bf16_f32 v55, v46, v47
  v_mfma_f32_32x32x16_bf16 v[80:95], v[48:51], a[196:199], v[80:95]
  s_nop 0
  s_waitcnt vmcnt(22)
  v_exp_f32 v32, v0
  v_exp_f32 v33, v1
  v_exp_f32_e64 v34, v2
  v_mfma_f32_32x32x16_bf16 v[80:95], v[52:55], a[200:203], v[80:95]
  s_waitcnt lgkmcnt(0)
  ds_read_b128 a[176:179], v108 offset:16384
  v_exp_f32 v35, v3
  v_exp_f32 v36, v4
  v_exp_f32 v37, v5
  v_mfma_f32_32x32x16_bf16 v[16:31], a[184:187], a[204:207], 0
  s_mov_b32 s14, 14
  ds_read_b128 a[180:183], v109 offset:16384
  v_exp_f32 v38, v6
  v_exp_f32 v39, v7
  v_exp_f32 v40, v8
  v_mfma_f32_32x32x16_bf16 v[16:31], a[188:191], a[208:211], v[16:31]
  ds_read_b128 a[196:199], v112 offset:13312
  v_exp_f32 v41, v9
  v_exp_f32 v42, v10
  v_exp_f32_e64 v43, v11
  v_mfma_f32_32x32x16_bf16 v[16:31], a[192:195], v[60:63], v[16:31]
  ds_read_b128 a[200:203], v112 offset:14336
  ds_read_b128 a[192:195], v112 offset:15360
  s_add_u32 s15, s59, 155648
  buffer_load_dwordx4 a[100:103], v159, s[36:39], s15 offen offset:1024
  buffer_load_dwordx4 a[104:107], v159, s[36:39], s15 offen offset:2048
  buffer_load_dwordx4 a[108:111], v159, s[36:39], s15 offen offset:3072
  s_add_u32 s15, s59, 159744
  buffer_load_dwordx4 a[112:115], v159, s[36:39], s15 offen offset:0
  s_and_b32 s70, s53, 3
  v_exp_f32 v44, v12
  v_exp_f32 v45, v13
  v_exp_f32 v46, v14
  v_exp_f32_e64 v47, v15
  v_pk_add_f32 v[32:33], v[32:33], 1.0
  v_pk_add_f32 v[34:35], v[34:35], 1.0
  v_pk_add_f32 v[36:37], v[36:37], 1.0
  v_pk_add_f32 v[38:39], v[38:39], 1.0
  v_pk_add_f32 v[40:41], v[40:41], 1.0
  v_pk_add_f32 v[42:43], v[42:43], 1.0
  v_pk_add_f32 v[44:45], v[44:45], 1.0
  v_pk_add_f32 v[46:47], v[46:47], 1.0
  v_rcp_f32 v32, v32
  v_rcp_f32 v33, v33
  v_rcp_f32 v34, v34
  v_rcp_f32 v35, v35
  v_rcp_f32 v36, v36
  v_rcp_f32 v37, v37
  v_rcp_f32 v38, v38
  v_rcp_f32 v39, v39
  v_rcp_f32 v40, v40
  v_rcp_f32 v41, v41
  v_rcp_f32 v42, v42
  v_rcp_f32 v43, v43
  v_rcp_f32 v44, v44
  v_rcp_f32 v45, v45
  v_rcp_f32 v46, v46
  v_rcp_f32 v47, v47
  v_pk_mul_f32 v[32:33], v[32:33], v[0:1]
  v_pk_mul_f32 v[34:35], v[34:35], v[2:3]
  v_pk_mul_f32 v[36:37], v[36:37], v[4:5]
  v_pk_mul_f32 v[38:39], v[38:39], v[6:7]
  v_pk_mul_f32 v[40:41], v[40:41], v[8:9]
  v_pk_mul_f32 v[42:43], v[42:43], v[10:11]
  v_pk_mul_f32 v[44:45], v[44:45], v[12:13]
  v_pk_mul_f32 v[46:47], v[46:47], v[14:15]
  v_cvt_pk_bf16_f32 v48, v32, v33
  v_cvt_pk_bf16_f32 v49, v34, v35
  v_cvt_pk_bf16_f32 v50, v36, v37
  v_cvt_pk_bf16_f32 v51, v38, v39
  v_cvt_pk_bf16_f32 v52, v40, v41
  v_cvt_pk_bf16_f32 v53, v42, v43
  v_cvt_pk_bf16_f32 v54, v44, v45
  v_cvt_pk_bf16_f32 v55, v46, v47
  s_cbranch_scc0 L_ret14
  s_bitcmp1_b32 s53, 0
  s_cbranch_scc0 L_iy14
  s_set_gpr_idx_on s55, gpr_idx(DST)
  v_cvt_pk_bf16_f32 v160, v64, v65
  v_cvt_pk_bf16_f32 v161, v66, v67
  v_cvt_pk_bf16_f32 v162, v68, v69
  v_cvt_pk_bf16_f32 v163, v70, v71
  v_cvt_pk_bf16_f32 v164, v72, v73
  v_cvt_pk_bf16_f32 v165, v74, v75
  v_cvt_pk_bf16_f32 v166, v76, v77
  v_cvt_pk_bf16_f32 v167, v78, v79
  v_cvt_pk_bf16_f32 v168, v80, v81
  v_cvt_pk_bf16_f32 v169, v82, v83
  v_cvt_pk_bf16_f32 v170, v84, v85
  v_cvt_pk_bf16_f32 v171, v86, v87
  v_cvt_pk_bf16_f32 v172, v88, v89
  v_cvt_pk_bf16_f32 v173, v90, v91
  v_cvt_pk_bf16_f32 v174, v92, v93
  v_cvt_pk_bf16_f32 v175, v94, v95
  s_set_gpr_idx_off
  s_add_u32 s55, s55, 16
  s_cmp_lg_u32 s76, 0
  s_cbranch_scc1 L_h_slow
  v_mfma_f32_32x32x16_bf16 v[64:79], a[212:215], a[212:215], 0
  v_mfma_f32_32x32x16_bf16 v[80:95], a[212:215], a[212:215], 0
L_iy14:
  s_bitcmp1_b32 s53, 1
  s_cbranch_scc0 L_ret14
  s_add_u32 s54, s54, 8
  s_set_gpr_idx_on s54, gpr_idx(SRC0)
  v_mov_b32 v56, v116
  v_mov_b32 v57, v117
  v_mov_b32 v58, v118
  v_mov_b32 v59, v119
  v_mov_b32 v60, v120
  v_mov_b32 v61, v121
  v_mov_b32 v62, v122
  v_mov_b32 v63, v123
  s_set_gpr_idx_off
L_ret14:
  s_waitcnt lgkmcnt(0)
  v_mfma_f32_32x32x16_bf16 v[64:79], v[48:51], a[196:199], v[64:79]
  s_mov_b32 m0, s48
  v_exp_f32 v32, v16
  v_exp_f32 v33, v17
  v_exp_f32 v34, v18
  v_add_u32 v100, v96, v104
  v_add_u32 v101, v97, v105
  v_add_u32 v102, v98, v106
  v_add_u32 v103, v99, v107
  v_mfma_f32_32x32x16_bf16 v[64:79], v[52:55], a[200:203], v[64:79]
  s_lshr_b32 s53, s53, 1
  ds_read_b128 v[96:99], v113 offset:1152
  v_exp_f32 v35, v19
  v_exp_f32 v36, v20
  v_exp_f32 v37, v21
  v_mfma_f32_32x32x16_bf16 v[0:15], a[176:179], a[204:207], 0
  ds_read_b128 a[184:187], v110 offset:16384
  v_exp_f32 v38, v22
  v_exp_f32 v39, v23
  v_exp_f32_e64 v40, v24
  v_mfma_f32_32x32x16_bf16 v[0:15], a[180:183], a[208:211], v[0:15]
  s_cmp_eq_u32 s53, 1
  ds_read_b128 a[188:191], v111 offset:16384
  v_exp_f32 v41, v25
  v_exp_f32 v42, v26
  v_exp_f32 v43, v27
  v_mfma_f32_32x32x16_bf16 v[0:15], a[192:195], v[56:59], v[0:15]
  s_add_u32 s15, s59, 159744
  buffer_load_dwordx4 a[116:119], v159, s[36:39], s15 offen offset:1024
  buffer_load_dwordx4 a[120:123], v159, s[36:39], s15 offen offset:2048
  buffer_load_dwordx4 a[124:127], v159, s[36:39], s15 offen offset:3072
  buffer_load_dwordx4 v100, s[16:19], s52 offen offset:0 lds
  buffer_load_dwordx4 v101, s[16:19], s52 offen offset:1024 lds
  buffer_load_dwordx4 v102, s[16:19], s52 offen offset:2048 lds
  buffer_load_dwordx4 v103, s[16:19], s52 offen offset:3072 lds
  v_exp_f32 v44, v28
  v_exp_f32 v45, v29
  v_exp_f32 v46, v30
  v_exp_f32 v47, v31
  v_pk_add_f32 v[32:33], v[32:33], 1.0
  v_pk_add_f32 v[34:35], v[34:35], 1.0
  v_pk_add_f32 v[36:37], v[36:37], 1.0
  v_pk_add_f32 v[38:39], v[38:39], 1.0
  v_pk_add_f32 v[40:41], v[40:41], 1.0
  v_pk_add_f32 v[42:43], v[42:43], 1.0
  v_pk_add_f32 v[44:45], v[44:45], 1.0
  v_pk_add_f32 v[46:47], v[46:47], 1.0
  v_rcp_f32 v32, v32
  v_rcp_f32 v33, v33
  v_rcp_f32 v34, v34
  v_rcp_f32 v35, v35
  v_rcp_f32 v36, v36
  v_rcp_f32 v37, v37
  v_rcp_f32 v38, v38
  v_rcp_f32 v39, v39
  v_rcp_f32 v40, v40
  v_rcp_f32 v41, v41
  v_rcp_f32 v42, v42
  v_rcp_f32 v43, v43
  v_rcp_f32 v44, v44
  v_rcp_f32 v45, v45
  v_rcp_f32 v46, v46
  v_rcp_f32 v47, v47
  v_pk_mul_f32 v[32:33], v[32:33], v[16:17]
  v_pk_mul_f32 v[34:35], v[34:35], v[18:19]
  v_pk_mul_f32 v[36:37], v[36:37], v[20:21]
  v_pk_mul_f32 v[38:39], v[38:39], v[22:23]
  v_pk_mul_f32 v[40:41], v[40:41], v[24:25]
  v_pk_mul_f32 v[42:43], v[42:43], v[26:27]
  v_pk_mul_f32 v[44:45], v[44:45], v[28:29]
  v_pk_mul_f32 v[46:47], v[46:47], v[30:31]
  v_cvt_pk_bf16_f32 v48, v32, v33
  v_cvt_pk_bf16_f32 v49, v34, v35
  v_cvt_pk_bf16_f32 v50, v36, v37
  v_cvt_pk_bf16_f32 v51, v38, v39
  v_cvt_pk_bf16_f32 v52, v40, v41
  v_cvt_pk_bf16_f32 v53, v42, v43
  v_cvt_pk_bf16_f32 v54, v44, v45
  v_cvt_pk_bf16_f32 v55, v46, v47
  v_add_u32 v112, 15360, v112
  v_add_u32 v113, 640, v113
L_loop:
  v_mfma_f32_32x32x16_bf16 v[80:95], v[48:51], a[196:199], v[80:95]
  s_waitcnt vmcnt(8)
  v_exp_f32 v32, v0
  v_exp_f32 v33, v1
  v_exp_f32 v34, v2
  v_mfma_f32_32x32x16_bf16 v[80:95], v[52:55], a[200:203], v[80:95]
  s_waitcnt lgkmcnt(0)
  ds_read_b128 a[176:179], v108 offset:32768
  v_exp_f32 v35, v3
  v_exp_f32 v36, v4
  v_exp_f32 v37, v5
  v_mfma_f32_32x32x16_bf16 v[16:31], a[184:187], a[204:207], 0
  s_mov_b32 s14, 0
  ds_read_b128 a[180:183], v109 offset:32768
  v_exp_f32 v38, v6
  v_exp_f32 v39, v7
  v_exp_f32 v40, v8
  v_mfma_f32_32x32x16_bf16 v[16:31], a[188:191], a[208:211], v[16:31]
  s_and_b32 s70, s53, 3
  ds_read_b128 a[196:199], v112 offset:1024
  v_exp_f32 v41, v9
  v_exp_f32 v42, v10
  v_exp_f32 v43, v11
  v_mfma_f32_32x32x16_bf16 v[16:31], a[192:195], v[60:63], v[16:31]
  ds_read_b128 a[200:203], v112 offset:2048
  ds_read_b128 a[192:195], v112 offset:3072
  v_exp_f32 v44, v12
  v_exp_f32 v45, v13
  v_exp_f32 v46, v14
  v_exp_f32 v47, v15
  v_pk_add_f32 v[32:33], v[32:33], 1.0
  v_pk_add_f32 v[34:35], v[34:35], 1.0
  v_pk_add_f32 v[36:37], v[36:37], 1.0
  v_pk_add_f32 v[38:39], v[38:39], 1.0
  v_pk_add_f32 v[40:41], v[40:41], 1.0
  v_pk_add_f32 v[42:43], v[42:43], 1.0
  v_pk_add_f32 v[44:45], v[44:45], 1.0
  v_pk_add_f32 v[46:47], v[46:47], 1.0
  v_rcp_f32 v32, v32
  v_rcp_f32 v33, v33
  v_rcp_f32 v34, v34
  v_rcp_f32 v35, v35
  v_rcp_f32 v36, v36
  v_rcp_f32 v37, v37
  v_rcp_f32 v38, v38
  v_rcp_f32 v39, v39
  v_rcp_f32 v40, v40
  v_rcp_f32 v41, v41
  v_rcp_f32 v42, v42
  v_rcp_f32 v43, v43
  v_rcp_f32 v44, v44
  v_rcp_f32 v45, v45
  v_rcp_f32 v46, v46
  v_rcp_f32 v47, v47
  v_pk_mul_f32 v[32:33], v[32:33], v[0:1]
  v_pk_mul_f32 v[34:35], v[34:35], v[2:3]
  v_pk_mul_f32 v[36:37], v[36:37], v[4:5]
  v_pk_mul_f32 v[38:39], v[38:39], v[6:7]
  v_pk_mul_f32 v[40:41], v[40:41], v[8:9]
  v_pk_mul_f32 v[42:43], v[42:43], v[10:11]
  v_pk_mul_f32 v[44:45], v[44:45], v[12:13]
  v_pk_mul_f32 v[46:47], v[46:47], v[14:15]
  v_cvt_pk_bf16_f32 v48, v32, v33
  v_cvt_pk_bf16_f32 v49, v34, v35
  v_cvt_pk_bf16_f32 v50, v36, v37
  v_cvt_pk_bf16_f32 v51, v38, v39
  v_cvt_pk_bf16_f32 v52, v40, v41
  v_cvt_pk_bf16_f32 v53, v42, v43
  v_cvt_pk_bf16_f32 v54, v44, v45
  v_cvt_pk_bf16_f32 v55, v46, v47
  s_cbranch_scc0 L_ret0
  s_bitcmp1_b32 s53, 0
  s_cbranch_scc0 L_iy0
  s_set_gpr_idx_on s55, gpr_idx(DST)
  v_cvt_pk_bf16_f32 v160, v64, v65
  v_cvt_pk_bf16_f32 v161, v66, v67
  v_cvt_pk_bf16_f32 v162, v68, v69
  v_cvt_pk_bf16_f32 v163, v70, v71
  v_cvt_pk_bf16_f32 v164, v72, v73
  v_cvt_pk_bf16_f32 v165, v74, v75
  v_cvt_pk_bf16_f32 v166, v76, v77
  v_cvt_pk_bf16_f32 v167, v78, v79
  v_cvt_pk_bf16_f32 v168, v80, v81
  v_cvt_pk_bf16_f32 v169, v82, v83
  v_cvt_pk_bf16_f32 v170, v84, v85
  v_cvt_pk_bf16_f32 v171, v86, v87
  v_cvt_pk_bf16_f32 v172, v88, v89
  v_cvt_pk_bf16_f32 v173, v90, v91
  v_cvt_pk_bf16_f32 v174, v92, v93
  v_cvt_pk_bf16_f32 v175, v94, v95
  s_set_gpr_idx_off
  s_add_u32 s55, s55, 16
  s_cmp_lg_u32 s76, 0
  s_cbranch_scc1 L_h_slow
  v_mfma_f32_32x32x16_bf16 v[64:79], a[212:215], a[212:215], 0
  v_mfma_f32_32x32x16_bf16 v[80:95], a[212:215], a[212:215], 0
L_iy0:
  s_bitcmp1_b32 s53, 1
  s_cbranch_scc0 L_ret0
  s_add_u32 s54, s54, 8
  s_set_gpr_idx_on s54, gpr_idx(SRC0)
  v_mov_b32 v56, v116
  v_mov_b32 v57, v117
  v_mov_b32 v58, v118
  v_mov_b32 v59, v119
  v_mov_b32 v60, v120
  v_mov_b32 v61, v121
  v_mov_b32 v62, v122
  v_mov_b32 v63, v123
  s_set_gpr_idx_off
L_ret0:
  s_waitcnt lgkmcnt(0)
  v_mfma_f32_32x32x16_bf16 v[64:79], v[48:51], a[196:199], v[64:79]
  s_mov_b32 m0, s49
  v_exp_f32 v32, v16
  v_exp_f32 v33, v17
  v_exp_f32 v34, v18
  v_add_u32 v100, v96, v104
  v_add_u32 v101, v97, v105
  v_add_u32 v102, v98, v106
  v_add_u32 v103, v99, v107
  v_mfma_f32_32x32x16_bf16 v[64:79], v[52:55], a[200:203], v[64:79]
  s_lshr_b32 s53, s53, 1
  ds_read_b128 v[96:99], v113 offset:640
  v_exp_f32 v35, v19
  v_exp_f32 v36, v20
  v_exp_f32 v37, v21
  v_mfma_f32_32x32x16_bf16 v[0:15], a[176:179], a[204:207], 0
  ds_read_b128 a[184:187], v110 offset:32768
  v_exp_f32 v38, v22
  v_exp_f32 v39, v23
  v_exp_f32_e64 v40, v24
  v_mfma_f32_32x32x16_bf16 v[0:15], a[180:183], a[208:211], v[0:15]
  s_cmp_eq_u32 s53, 1
  ds_read_b128 a[188:191], v111 offset:32768
  v_exp_f32 v41, v25
  v_exp_f32 v42, v26
  v_exp_f32 v43, v27
  v_mfma_f32_32x32x16_bf16 v[0:15], a[192:195], v[56:59], v[0:15]
  buffer_load_dwordx4 v100, s[16:19], s52 offen offset:0 lds
  buffer_load_dwordx4 v101, s[16:19], s52 offen offset:1024 lds
  buffer_load_dwordx4 v102, s[16:19], s52 offen offset:2048 lds
  buffer_load_dwordx4 v103, s[16:19], s52 offen offset:3072 lds
  v_exp_f32 v44, v28
  v_exp_f32 v45, v29
  v_exp_f32 v46, v30
  v_exp_f32 v47, v31
  v_pk_add_f32 v[32:33], v[32:33], 1.0
  v_pk_add_f32 v[34:35], v[34:35], 1.0
  v_pk_add_f32 v[36:37], v[36:37], 1.0
  v_pk_add_f32 v[38:39], v[38:39], 1.0
  v_pk_add_f32 v[40:41], v[40:41], 1.0
  v_pk_add_f32 v[42:43], v[42:43], 1.0
  v_pk_add_f32 v[44:45], v[44:45], 1.0
  v_pk_add_f32 v[46:47], v[46:47], 1.0
  v_rcp_f32 v32, v32
  v_rcp_f32 v33, v33
  v_rcp_f32 v34, v34
  v_rcp_f32 v35, v35
  v_rcp_f32 v36, v36
  v_rcp_f32 v37, v37
  v_rcp_f32 v38, v38
  v_rcp_f32 v39, v39
  v_rcp_f32 v40, v40
  v_rcp_f32 v41, v41
  v_rcp_f32 v42, v42
  v_rcp_f32 v43, v43
  v_rcp_f32 v44, v44
  v_rcp_f32 v45, v45
  v_rcp_f32 v46, v46
  v_rcp_f32 v47, v47
  v_pk_mul_f32 v[32:33], v[32:33], v[16:17]
  v_pk_mul_f32 v[34:35], v[34:35], v[18:19]
  v_pk_mul_f32 v[36:37], v[36:37], v[20:21]
  v_pk_mul_f32 v[38:39], v[38:39], v[22:23]
  v_pk_mul_f32 v[40:41], v[40:41], v[24:25]
  v_pk_mul_f32 v[42:43], v[42:43], v[26:27]
  v_pk_mul_f32 v[44:45], v[44:45], v[28:29]
  v_pk_mul_f32 v[46:47], v[46:47], v[30:31]
  v_cvt_pk_bf16_f32 v48, v32, v33
  v_cvt_pk_bf16_f32 v49, v34, v35
  v_cvt_pk_bf16_f32 v50, v36, v37
  v_cvt_pk_bf16_f32 v51, v38, v39
  v_cvt_pk_bf16_f32 v52, v40, v41
  v_cvt_pk_bf16_f32 v53, v42, v43
  v_cvt_pk_bf16_f32 v54, v44, v45
  v_cvt_pk_bf16_f32 v55, v46, v47
  s_cbranch_scc1 L_loop_done
  v_mfma_f32_32x32x16_bf16 v[80:95], v[48:51], a[196:199], v[80:95]
  s_waitcnt vmcnt(8)
  v_exp_f32 v32, v0
  v_exp_f32 v33, v1
  v_exp_f32_e64 v34, v2
  v_mfma_f32_32x32x16_bf16 v[80:95], v[52:55], a[200:203], v[80:95]
  s_waitcnt lgkmcnt(0)
  ds_read_b128 a[176:179], v108 offset:49152
  v_exp_f32 v35, v3
  v_exp_f32 v36, v4
  v_exp_f32 v37, v5
  v_mfma_f32_32x32x16_bf16 v[16:31], a[184:187], a[204:207], 0
  s_mov_b32 s14, 1
  ds_read_b128 a[180:183], v109 offset:49152
  v_exp_f32 v38, v6
  v_exp_f32 v39, v7
  v_exp_f32 v40, v8
  v_mfma_f32_32x32x16_bf16 v[16:31], a[188:191], a[208:211], v[16:31]
  s_and_b32 s70, s53, 3
  ds_read_b128 a[196:199], v112 offset:4096
  v_exp_f32 v41, v9
  v_exp_f32 v42, v10
  v_exp_f32 v43, v11
  v_mfma_f32_32x32x16_bf16 v[16:31], a[192:195], v[60:63], v[16:31]
  ds_read_b128 a[200:203], v112 offset:5120
  ds_read_b128 a[192:195], v112 offset:6144
  v_exp_f32 v44, v12
  v_exp_f32 v45, v13
  v_exp_f32 v46, v14
  v_exp_f32 v47, v15
  v_pk_add_f32 v[32:33], v[32:33], 1.0
  v_pk_add_f32 v[34:35], v[34:35], 1.0
  v_pk_add_f32 v[36:37], v[36:37], 1.0
  v_pk_add_f32 v[38:39], v[38:39], 1.0
  v_pk_add_f32 v[40:41], v[40:41], 1.0
  v_pk_add_f32 v[42:43], v[42:43], 1.0
  v_pk_add_f32 v[44:45], v[44:45], 1.0
  v_pk_add_f32 v[46:47], v[46:47], 1.0
  v_rcp_f32 v32, v32
  v_rcp_f32 v33, v33
  v_rcp_f32 v34, v34
  v_rcp_f32 v35, v35
  v_rcp_f32 v36, v36
  v_rcp_f32 v37, v37
  v_rcp_f32 v38, v38
  v_rcp_f32 v39, v39
  v_rcp_f32 v40, v40
  v_rcp_f32 v41, v41
  v_rcp_f32 v42, v42
  v_rcp_f32 v43, v43
  v_rcp_f32 v44, v44
  v_rcp_f32 v45, v45
  v_rcp_f32 v46, v46
  v_rcp_f32 v47, v47
  v_pk_mul_f32 v[32:33], v[32:33], v[0:1]
  v_pk_mul_f32 v[34:35], v[34:35], v[2:3]
  v_pk_mul_f32 v[36:37], v[36:37], v[4:5]
  v_pk_mul_f32 v[38:39], v[38:39], v[6:7]
  v_pk_mul_f32 v[40:41], v[40:41], v[8:9]
  v_pk_mul_f32 v[42:43], v[42:43], v[10:11]
  v_pk_mul_f32 v[44:45], v[44:45], v[12:13]
  v_pk_mul_f32 v[46:47], v[46:47], v[14:15]
  v_cvt_pk_bf16_f32 v48, v32, v33
  v_cvt_pk_bf16_f32 v49, v34, v35
  v_cvt_pk_bf16_f32 v50, v36, v37
  v_cvt_pk_bf16_f32 v51, v38, v39
  v_cvt_pk_bf16_f32 v52, v40, v41
  v_cvt_pk_bf16_f32 v53, v42, v43
  v_cvt_pk_bf16_f32 v54, v44, v45
  v_cvt_pk_bf16_f32 v55, v46, v47
  s_cbranch_scc0 L_ret1
  s_bitcmp1_b32 s53, 0
  s_cbranch_scc0 L_iy1
  s_set_gpr_idx_on s55, gpr_idx(DST)
  v_cvt_pk_bf16_f32 v160, v64, v65
  v_cvt_pk_bf16_f32 v161, v66, v67
  v_cvt_pk_bf16_f32 v162, v68, v69
  v_cvt_pk_bf16_f32 v163, v70, v71
  v_cvt_pk_bf16_f32 v164, v72, v73
  v_cvt_pk_bf16_f32 v165, v74, v75
  v_cvt_pk_bf16_f32 v166, v76, v77
  v_cvt_pk_bf16_f32 v167, v78, v79
  v_cvt_pk_bf16_f32 v168, v80, v81
  v_cvt_pk_bf16_f32 v169, v82, v83
  v_cvt_pk_bf16_f32 v170, v84, v85
  v_cvt_pk_bf16_f32 v171, v86, v87
  v_cvt_pk_bf16_f32 v172, v88, v89
  v_cvt_pk_bf16_f32 v173, v90, v91
  v_cvt_pk_bf16_f32 v174, v92, v93
  v_cvt_pk_bf16_f32 v175, v94, v95
  s_set_gpr_idx_off
  s_add_u32 s55, s55, 16
  s_cmp_lg_u32 s76, 0
  s_cbranch_scc1 L_h_slow
  v_mfma_f32_32x32x16_bf16 v[64:79], a[212:215], a[212:215], 0
  v_mfma_f32_32x32x16_bf16 v[80:95], a[212:215], a[212:215], 0
L_iy1:
  s_bitcmp1_b32 s53, 1
  s_cbranch_scc0 L_ret1
  s_add_u32 s54, s54, 8
  s_set_gpr_idx_on s54, gpr_idx(SRC0)
  v_mov_b32 v56, v116
  v_mov_b32 v57, v117
  v_mov_b32 v58, v118
  v_mov_b32 v59, v119
  v_mov_b32 v60, v120
  v_mov_b32 v61, v121
  v_mov_b32 v62, v122
  v_mov_b32 v63, v123
  s_set_gpr_idx_off
L_ret1:
  s_waitcnt lgkmcnt(0)
  v_mfma_f32_32x32x16_bf16 v[64:79], v[48:51], a[196:199], v[64:79]
  s_mov_b32 m0, s50
  v_exp_f32 v32, v16
  v_exp_f32 v33, v17
  v_exp_f32 v34, v18
  v_add_u32 v100, v96, v104
  v_add_u32 v101, v97, v105
  v_add_u32 v102, v98, v106
  v_add_u32 v103, v99, v107
  v_mfma_f32_32x32x16_bf16 v[64:79], v[52:55], a[200:203], v[64:79]
  s_lshr_b32 s53, s53, 1
  ds_read_b128 v[96:99], v113 offset:768
  v_exp_f32 v35, v19
  v_exp_f32 v36, v20
  v_exp_f32 v37, v21
  v_mfma_f32_32x32x16_bf16 v[0:15], a[176:179], a[204:207], 0
  ds_read_b128 a[184:187], v110 offset:49152
  v_exp_f32 v38, v22
  v_exp_f32 v39, v23
  v_exp_f32_e64 v40, v24
  v_mfma_f32_32x32x16_bf16 v[0:15], a[180:183], a[208:211], v[0:15]
  s_cmp_eq_u32 s53, 1
  ds_read_b128 a[188:191], v111 offset:49152
  v_exp_f32 v41, v25
  v_exp_f32 v42, v26
  v_exp_f32 v43, v27
  v_mfma_f32_32x32x16_bf16 v[0:15], a[192:195], v[56:59], v[0:15]
  buffer_load_dwordx4 v100, s[16:19], s52 offen offset:0 lds
  buffer_load_dwordx4 v101, s[16:19], s52 offen offset:1024 lds
  buffer_load_dwordx4 v102, s[16:19], s52 offen offset:2048 lds
  buffer_load_dwordx4 v103, s[16:19], s52 offen offset:3072 lds
  v_exp_f32 v44, v28
  v_exp_f32 v45, v29
  v_exp_f32 v46, v30
  v_exp_f32 v47, v31
  v_pk_add_f32 v[32:33], v[32:33], 1.0
  v_pk_add_f32 v[34:35], v[34:35], 1.0
  v_pk_add_f32 v[36:37], v[36:37], 1.0
  v_pk_add_f32 v[38:39], v[38:39], 1.0
  v_pk_add_f32 v[40:41], v[40:41], 1.0
  v_pk_add_f32 v[42:43], v[42:43], 1.0
  v_pk_add_f32 v[44:45], v[44:45], 1.0
  v_pk_add_f32 v[46:47], v[46:47], 1.0
  v_rcp_f32 v32, v32
  v_rcp_f32 v33, v33
  v_rcp_f32 v34, v34
  v_rcp_f32 v35, v35
  v_rcp_f32 v36, v36
  v_rcp_f32 v37, v37
  v_rcp_f32 v38, v38
  v_rcp_f32 v39, v39
  v_rcp_f32 v40, v40
  v_rcp_f32 v41, v41
  v_rcp_f32 v42, v42
  v_rcp_f32 v43, v43
  v_rcp_f32 v44, v44
  v_rcp_f32 v45, v45
  v_rcp_f32 v46, v46
  v_rcp_f32 v47, v47
  v_pk_mul_f32 v[32:33], v[32:33], v[16:17]
  v_pk_mul_f32 v[34:35], v[34:35], v[18:19]
  v_pk_mul_f32 v[36:37], v[36:37], v[20:21]
  v_pk_mul_f32 v[38:39], v[38:39], v[22:23]
  v_pk_mul_f32 v[40:41], v[40:41], v[24:25]
  v_pk_mul_f32 v[42:43], v[42:43], v[26:27]
  v_pk_mul_f32 v[44:45], v[44:45], v[28:29]
  v_pk_mul_f32 v[46:47], v[46:47], v[30:31]
  v_cvt_pk_bf16_f32 v48, v32, v33
  v_cvt_pk_bf16_f32 v49, v34, v35
  v_cvt_pk_bf16_f32 v50, v36, v37
  v_cvt_pk_bf16_f32 v51, v38, v39
  v_cvt_pk_bf16_f32 v52, v40, v41
  v_cvt_pk_bf16_f32 v53, v42, v43
  v_cvt_pk_bf16_f32 v54, v44, v45
  v_cvt_pk_bf16_f32 v55, v46, v47
  s_cbranch_scc1 L_loop_done
  v_mfma_f32_32x32x16_bf16 v[80:95], v[48:51], a[196:199], v[80:95]
  s_waitcnt vmcnt(8)
  v_exp_f32 v32, v0
  v_exp_f32 v33, v1
  v_exp_f32_e64 v34, v2
  v_mfma_f32_32x32x16_bf16 v[80:95], v[52:55], a[200:203], v[80:95]
  s_waitcnt lgkmcnt(0)
  ds_read_b128 a[176:179], v108 offset:0
  v_exp_f32 v35, v3
  v_exp_f32 v36, v4
  v_exp_f32 v37, v5
  v_mfma_f32_32x32x16_bf16 v[16:31], a[184:187], a[204:207], 0
  s_mov_b32 s14, 2
  ds_read_b128 a[180:183], v109 offset:0
  v_exp_f32 v38, v6
  v_exp_f32 v39, v7
  v_exp_f32 v40, v8
  v_mfma_f32_32x32x16_bf16 v[16:31], a[188:191], a[208:211], v[16:31]
  s_and_b32 s70, s53, 3
  ds_read_b128 a[196:199], v112 offset:7168
  v_exp_f32 v41, v9
  v_exp_f32 v42, v10
  v_exp_f32 v43, v11
  v_mfma_f32_32x32x16_bf16 v[16:31], a[192:195], v[60:63], v[16:31]
  ds_read_b128 a[200:203], v112 offset:8192
  ds_read_b128 a[192:195], v112 offset:9216
  v_exp_f32 v44, v12
  v_exp_f32 v45, v13
  v_exp_f32 v46, v14
  v_exp_f32 v47, v15
  v_pk_add_f32 v[32:33], v[32:33], 1.0
  v_pk_add_f32 v[34:35], v[34:35], 1.0
  v_pk_add_f32 v[36:37], v[36:37], 1.0
  v_pk_add_f32 v[38:39], v[38:39], 1.0
  v_pk_add_f32 v[40:41], v[40:41], 1.0
  v_pk_add_f32 v[42:43], v[42:43], 1.0
  v_pk_add_f32 v[44:45], v[44:45], 1.0
  v_pk_add_f32 v[46:47], v[46:47], 1.0
  v_rcp_f32 v32, v32
  v_rcp_f32 v33, v33
  v_rcp_f32 v34, v34
  v_rcp_f32 v35, v35
  v_rcp_f32 v36, v36
  v_rcp_f32 v37, v37
  v_rcp_f32 v38, v38
  v_rcp_f32 v39, v39
  v_rcp_f32 v40, v40
  v_rcp_f32 v41, v41
  v_rcp_f32 v42, v42
  v_rcp_f32 v43, v43
  v_rcp_f32 v44, v44
  v_rcp_f32 v45, v45
  v_rcp_f32 v46, v46
  v_rcp_f32 v47, v47
  v_pk_mul_f32 v[32:33], v[32:33], v[0:1]
  v_pk_mul_f32 v[34:35], v[34:35], v[2:3]
  v_pk_mul_f32 v[36:37], v[36:37], v[4:5]
  v_pk_mul_f32 v[38:39], v[38:39], v[6:7]
  v_pk_mul_f32 v[40:41], v[40:41], v[8:9]
  v_pk_mul_f32 v[42:43], v[42:43], v[10:11]
  v_pk_mul_f32 v[44:45], v[44:45], v[12:13]
  v_pk_mul_f32 v[46:47], v[46:47], v[14:15]
  v_cvt_pk_bf16_f32 v48, v32, v33
  v_cvt_pk_bf16_f32 v49, v34, v35
  v_cvt_pk_bf16_f32 v50, v36, v37
  v_cvt_pk_bf16_f32 v51, v38, v39
  v_cvt_pk_bf16_f32 v52, v40, v41
  v_cvt_pk_bf16_f32 v53, v42, v43
  v_cvt_pk_bf16_f32 v54, v44, v45
  v_cvt_pk_bf16_f32 v55, v46, v47
  s_cbranch_scc0 L_ret2
  s_bitcmp1_b32 s53, 0
  s_cbranch_scc0 L_iy2
  s_set_gpr_idx_on s55, gpr_idx(DST)
  v_cvt_pk_bf16_f32 v160, v64, v65
  v_cvt_pk_bf16_f32 v161, v66, v67
  v_cvt_pk_bf16_f32 v162, v68, v69
  v_cvt_pk_bf16_f32 v163, v70, v71
  v_cvt_pk_bf16_f32 v164, v72, v73
  v_cvt_pk_bf16_f32 v165, v74, v75
  v_cvt_pk_bf16_f32 v166, v76, v77
  v_cvt_pk_bf16_f32 v167, v78, v79
  v_cvt_pk_bf16_f32 v168, v80, v81
  v_cvt_pk_bf16_f32 v169, v82, v83
  v_cvt_pk_bf16_f32 v170, v84, v85
  v_cvt_pk_bf16_f32 v171, v86, v87
  v_cvt_pk_bf16_f32 v172, v88, v89
  v_cvt_pk_bf16_f32 v173, v90, v91
  v_cvt_pk_bf16_f32 v174, v92, v93
  v_cvt_pk_bf16_f32 v175, v94, v95
  s_set_gpr_idx_off
  s_add_u32 s55, s55, 16
  s_cmp_lg_u32 s76, 0
  s_cbranch_scc1 L_h_slow
  v_mfma_f32_32x32x16_bf16 v[64:79], a[212:215], a[212:215], 0
  v_mfma_f32_32x32x16_bf16 v[80:95], a[212:215], a[212:215], 0
L_iy2:
  s_bitcmp1_b32 s53, 1
  s_cbranch_scc0 L_ret2
  s_add_u32 s54, s54, 8
  s_set_gpr_idx_on s54, gpr_idx(SRC0)
  v_mov_b32 v56, v116
  v_mov_b32 v57, v117
  v_mov_b32 v58, v118
  v_mov_b32 v59, v119
  v_mov_b32 v60, v120
  v_mov_b32 v61, v121
  v_mov_b32 v62, v122
  v_mov_b32 v63, v123
  s_set_gpr_idx_off
L_ret2:
  s_waitcnt lgkmcnt(0)
  v_mfma_f32_32x32x16_bf16 v[64:79], v[48:51], a[196:199], v[64:79]
  s_mov_b32 m0, s51
  v_exp_f32 v32, v16
  v_exp_f32 v33, v17
  v_exp_f32 v34, v18
  v_add_u32 v100, v96, v104
  v_add_u32 v101, v97, v105
  v_add_u32 v102, v98, v106
  v_add_u32 v103, v99, v107
  v_mfma_f32_32x32x16_bf16 v[64:79], v[52:55], a[200:203], v[64:79]
  s_lshr_b32 s53, s53, 1
  ds_read_b128 v[96:99], v113 offset:896
  v_exp_f32 v35, v19
  v_exp_f32 v36, v20
  v_exp_f32 v37, v21
  v_mfma_f32_32x32x16_bf16 v[0:15], a[176:179], a[204:207], 0
  ds_read_b128 a[184:187], v110 offset:0
  v_exp_f32 v38, v22
  v_exp_f32 v39, v23
  v_exp_f32_e64 v40, v24
  v_mfma_f32_32x32x16_bf16 v[0:15], a[180:183], a[208:211], v[0:15]
  s_cmp_eq_u32 s53, 1
  ds_read_b128 a[188:191], v111 offset:0
  v_exp_f32 v41, v25
  v_exp_f32 v42, v26
  v_exp_f32 v43, v27
  v_mfma_f32_32x32x16_bf16 v[0:15], a[192:195], v[56:59], v[0:15]
  buffer_load_dwordx4 v100, s[16:19], s52 offen offset:0 lds
  buffer_load_dwordx4 v101, s[16:19], s52 offen offset:1024 lds
  buffer_load_dwordx4 v102, s[16:19], s52 offen offset:2048 lds
  buffer_load_dwordx4 v103, s[16:19], s52 offen offset:3072 lds
  v_exp_f32 v44, v28
  v_exp_f32 v45, v29
  v_exp_f32 v46, v30
  v_exp_f32 v47, v31
  v_pk_add_f32 v[32:33], v[32:33], 1.0
  v_pk_add_f32 v[34:35], v[34:35], 1.0
  v_pk_add_f32 v[36:37], v[36:37], 1.0
  v_pk_add_f32 v[38:39], v[38:39], 1.0
  v_pk_add_f32 v[40:41], v[40:41], 1.0
  v_pk_add_f32 v[42:43], v[42:43], 1.0
  v_pk_add_f32 v[44:45], v[44:45], 1.0
  v_pk_add_f32 v[46:47], v[46:47], 1.0
  v_rcp_f32 v32, v32
  v_rcp_f32 v33, v33
  v_rcp_f32 v34, v34
  v_rcp_f32 v35, v35
  v_rcp_f32 v36, v36
  v_rcp_f32 v37, v37
  v_rcp_f32 v38, v38
  v_rcp_f32 v39, v39
  v_rcp_f32 v40, v40
  v_rcp_f32 v41, v41
  v_rcp_f32 v42, v42
  v_rcp_f32 v43, v43
  v_rcp_f32 v44, v44
  v_rcp_f32 v45, v45
  v_rcp_f32 v46, v46
  v_rcp_f32 v47, v47
  v_pk_mul_f32 v[32:33], v[32:33], v[16:17]
  v_pk_mul_f32 v[34:35], v[34:35], v[18:19]
  v_pk_mul_f32 v[36:37], v[36:37], v[20:21]
  v_pk_mul_f32 v[38:39], v[38:39], v[22:23]
  v_pk_mul_f32 v[40:41], v[40:41], v[24:25]
  v_pk_mul_f32 v[42:43], v[42:43], v[26:27]
  v_pk_mul_f32 v[44:45], v[44:45], v[28:29]
  v_pk_mul_f32 v[46:47], v[46:47], v[30:31]
  v_cvt_pk_bf16_f32 v48, v32, v33
  v_cvt_pk_bf16_f32 v49, v34, v35
  v_cvt_pk_bf16_f32 v50, v36, v37
  v_cvt_pk_bf16_f32 v51, v38, v39
  v_cvt_pk_bf16_f32 v52, v40, v41
  v_cvt_pk_bf16_f32 v53, v42, v43
  v_cvt_pk_bf16_f32 v54, v44, v45
  v_cvt_pk_bf16_f32 v55, v46, v47
  s_cbranch_scc1 L_loop_done
  v_mfma_f32_32x32x16_bf16 v[80:95], v[48:51], a[196:199], v[80:95]
  s_waitcnt vmcnt(8)
  v_exp_f32 v32, v0
  v_exp_f32 v33, v1
  v_exp_f32_e64 v34, v2
  v_mfma_f32_32x32x16_bf16 v[80:95], v[52:55], a[200:203], v[80:95]
  s_waitcnt lgkmcnt(0)
  ds_read_b128 a[176:179], v108 offset:16384
  v_exp_f32 v35, v3
  v_exp_f32 v36, v4
  v_exp_f32 v37, v5
  v_mfma_f32_32x32x16_bf16 v[16:31], a[184:187], a[204:207], 0
  s_mov_b32 s14, 3
  ds_read_b128 a[180:183], v109 offset:16384
  v_exp_f32 v38, v6
  v_exp_f32 v39, v7
  v_exp_f32 v40, v8
  v_mfma_f32_32x32x16_bf16 v[16:31], a[188:191], a[208:211], v[16:31]
  s_and_b32 s70, s53, 3
  ds_read_b128 a[196:199], v112 offset:10240
  v_exp_f32 v41, v9
  v_exp_f32 v42, v10
  v_exp_f32 v43, v11
  v_mfma_f32_32x32x16_bf16 v[16:31], a[192:195], v[60:63], v[16:31]
  ds_read_b128 a[200:203], v112 offset:11264
  ds_read_b128 a[192:195], v112 offset:12288
  v_exp_f32 v44, v12
  v_exp_f32 v45, v13
  v_exp_f32 v46, v14
  v_exp_f32 v47, v15
  v_pk_add_f32 v[32:33], v[32:33], 1.0
  v_pk_add_f32 v[34:35], v[34:35], 1.0
  v_pk_add_f32 v[36:37], v[36:37], 1.0
  v_pk_add_f32 v[38:39], v[38:39], 1.0
  v_pk_add_f32 v[40:41], v[40:41], 1.0
  v_pk_add_f32 v[42:43], v[42:43], 1.0
  v_pk_add_f32 v[44:45], v[44:45], 1.0
  v_pk_add_f32 v[46:47], v[46:47], 1.0
  v_rcp_f32 v32, v32
  v_rcp_f32 v33, v33
  v_rcp_f32 v34, v34
  v_rcp_f32 v35, v35
  v_rcp_f32 v36, v36
  v_rcp_f32 v37, v37
  v_rcp_f32 v38, v38
  v_rcp_f32 v39, v39
  v_rcp_f32 v40, v40
  v_rcp_f32 v41, v41
  v_rcp_f32 v42, v42
  v_rcp_f32 v43, v43
  v_rcp_f32 v44, v44
  v_rcp_f32 v45, v45
  v_rcp_f32 v46, v46
  v_rcp_f32 v47, v47
  v_pk_mul_f32 v[32:33], v[32:33], v[0:1]
  v_pk_mul_f32 v[34:35], v[34:35], v[2:3]
  v_pk_mul_f32 v[36:37], v[36:37], v[4:5]
  v_pk_mul_f32 v[38:39], v[38:39], v[6:7]
  v_pk_mul_f32 v[40:41], v[40:41], v[8:9]
  v_pk_mul_f32 v[42:43], v[42:43], v[10:11]
  v_pk_mul_f32 v[44:45], v[44:45], v[12:13]
  v_pk_mul_f32 v[46:47], v[46:47], v[14:15]
  v_cvt_pk_bf16_f32 v48, v32, v33
  v_cvt_pk_bf16_f32 v49, v34, v35
  v_cvt_pk_bf16_f32 v50, v36, v37
  v_cvt_pk_bf16_f32 v51, v38, v39
  v_cvt_pk_bf16_f32 v52, v40, v41
  v_cvt_pk_bf16_f32 v53, v42, v43
  v_cvt_pk_bf16_f32 v54, v44, v45
  v_cvt_pk_bf16_f32 v55, v46, v47
  s_cbranch_scc0 L_ret3
  s_bitcmp1_b32 s53, 0
  s_cbranch_scc0 L_iy3
  s_set_gpr_idx_on s55, gpr_idx(DST)
  v_cvt_pk_bf16_f32 v160, v64, v65
  v_cvt_pk_bf16_f32 v161, v66, v67
  v_cvt_pk_bf16_f32 v162, v68, v69
  v_cvt_pk_bf16_f32 v163, v70, v71
  v_cvt_pk_bf16_f32 v164, v72, v73
  v_cvt_pk_bf16_f32 v165, v74, v75
  v_cvt_pk_bf16_f32 v166, v76, v77
  v_cvt_pk_bf16_f32 v167, v78, v79
  v_cvt_pk_bf16_f32 v168, v80, v81
  v_cvt_pk_bf16_f32 v169, v82, v83
  v_cvt_pk_bf16_f32 v170, v84, v85
  v_cvt_pk_bf16_f32 v171, v86, v87
  v_cvt_pk_bf16_f32 v172, v88, v89
  v_cvt_pk_bf16_f32 v173, v90, v91
  v_cvt_pk_bf16_f32 v174, v92, v93
  v_cvt_pk_bf16_f32 v175, v94, v95
  s_set_gpr_idx_off
  s_add_u32 s55, s55, 16
  s_cmp_lg_u32 s76, 0
  s_cbranch_scc1 L_h_slow
  v_mfma_f32_32x32x16_bf16 v[64:79], a[212:215], a[212:215], 0
  v_mfma_f32_32x32x16_bf16 v[80:95], a[212:215], a[212:215], 0
L_iy3:
  s_bitcmp1_b32 s53, 1
  s_cbranch_scc0 L_ret3
  s_add_u32 s54, s54, 8
  s_set_gpr_idx_on s54, gpr_idx(SRC0)
  v_mov_b32 v56, v116
  v_mov_b32 v57, v117
  v_mov_b32 v58, v118
  v_mov_b32 v59, v119
  v_mov_b32 v60, v120
  v_mov_b32 v61, v121
  v_mov_b32 v62, v122
  v_mov_b32 v63, v123
  s_set_gpr_idx_off
L_ret3:
  s_waitcnt lgkmcnt(0)
  v_mfma_f32_32x32x16_bf16 v[64:79], v[48:51], a[196:199], v[64:79]
  s_mov_b32 m0, s48
  v_exp_f32 v32, v16
  v_exp_f32 v33, v17
  v_exp_f32 v34, v18
  v_add_u32 v100, v96, v104
  v_add_u32 v101, v97, v105
  v_add_u32 v102, v98, v106
  v_add_u32 v103, v99, v107
  v_mfma_f32_32x32x16_bf16 v[64:79], v[52:55], a[200:203], v[64:79]
  s_lshr_b32 s53, s53, 1
  ds_read_b128 v[96:99], v113 offset:1024
  v_exp_f32 v35, v19
  v_exp_f32 v36, v20
  v_exp_f32 v37, v21
  v_mfma_f32_32x32x16_bf16 v[0:15], a[176:179], a[204:207], 0
  ds_read_b128 a[184:187], v110 offset:16384
  v_exp_f32 v38, v22
  v_exp_f32 v39, v23
  v_exp_f32_e64 v40, v24
  v_mfma_f32_32x32x16_bf16 v[0:15], a[180:183], a[208:211], v[0:15]
  s_cmp_eq_u32 s53, 1
  ds_read_b128 a[188:191], v111 offset:16384
  v_exp_f32 v41, v25
  v_exp_f32 v42, v26
  v_exp_f32 v43, v27
  v_mfma_f32_32x32x16_bf16 v[0:15], a[192:195], v[56:59], v[0:15]
  buffer_load_dwordx4 v100, s[16:19], s52 offen offset:0 lds
  buffer_load_dwordx4 v101, s[16:19], s52 offen offset:1024 lds
  buffer_load_dwordx4 v102, s[16:19], s52 offen offset:2048 lds
  buffer_load_dwordx4 v103, s[16:19], s52 offen offset:3072 lds
  v_exp_f32 v44, v28
  v_exp_f32 v45, v29
  v_exp_f32 v46, v30
  v_exp_f32 v47, v31
  v_pk_add_f32 v[32:33], v[32:33], 1.0
  v_pk_add_f32 v[34:35], v[34:35], 1.0
  v_pk_add_f32 v[36:37], v[36:37], 1.0
  v_pk_add_f32 v[38:39], v[38:39], 1.0
  v_pk_add_f32 v[40:41], v[40:41], 1.0
  v_pk_add_f32 v[42:43], v[42:43], 1.0
  v_pk_add_f32 v[44:45], v[44:45], 1.0
  v_pk_add_f32 v[46:47], v[46:47], 1.0
  v_rcp_f32 v32, v32
  v_rcp_f32 v33, v33
  v_rcp_f32 v34, v34
  v_rcp_f32 v35, v35
  v_rcp_f32 v36, v36
  v_rcp_f32 v37, v37
  v_rcp_f32 v38, v38
  v_rcp_f32 v39, v39
  v_rcp_f32 v40, v40
  v_rcp_f32 v41, v41
  v_rcp_f32 v42, v42
  v_rcp_f32 v43, v43
  v_rcp_f32 v44, v44
  v_rcp_f32 v45, v45
  v_rcp_f32 v46, v46
  v_rcp_f32 v47, v47
  v_pk_mul_f32 v[32:33], v[32:33], v[16:17]
  v_pk_mul_f32 v[34:35], v[34:35], v[18:19]
  v_pk_mul_f32 v[36:37], v[36:37], v[20:21]
  v_pk_mul_f32 v[38:39], v[38:39], v[22:23]
  v_pk_mul_f32 v[40:41], v[40:41], v[24:25]
  v_pk_mul_f32 v[42:43], v[42:43], v[26:27]
  v_pk_mul_f32 v[44:45], v[44:45], v[28:29]
  v_pk_mul_f32 v[46:47], v[46:47], v[30:31]
  v_cvt_pk_bf16_f32 v48, v32, v33
  v_cvt_pk_bf16_f32 v49, v34, v35
  v_cvt_pk_bf16_f32 v50, v36, v37
  v_cvt_pk_bf16_f32 v51, v38, v39
  v_cvt_pk_bf16_f32 v52, v40, v41
  v_cvt_pk_bf16_f32 v53, v42, v43
  v_cvt_pk_bf16_f32 v54, v44, v45
  v_cvt_pk_bf16_f32 v55, v46, v47
  s_cbranch_scc1 L_loop_done
  v_add_u32 v112, 12288, v112
  v_add_u32 v113, 512, v113
  s_branch L_loop
L_loop_done:
  v_mfma_f32_32x32x16_bf16 v[80:95], v[48:51], a[196:199], v[80:95]
  v_mfma_f32_32x32x16_bf16 v[80:95], v[52:55], a[200:203], v[80:95]
  s_waitcnt lgkmcnt(0)
  v_lshrrev_b32 v3, 5, v115
  v_and_b32 v5, 31, v115
  s_lshl_b32 s70, s12, 1
  v_add_u32 v4, s70, v3
  v_xor_b32 v4, v4, v5
  v_lshlrev_b32 v4, 4, v4
  v_lshl_add_u32 v8, v3, 9, v4
  v_xor_b32 v9, 0x80, v8
  s_lshl_b32 s70, s12, 10
  s_add_u32 s71, s70, 65536
  s_barrier
  s_add_u32 m0, s71, 0
  s_add_u32 s72, s70, 0
  buffer_load_dwordx4 v8, s[32:35], s72 offen lds
  s_add_u32 m0, s71, 4096
  s_add_u32 s72, s70, 4096
  buffer_load_dwordx4 v9, s[32:35], s72 offen lds
  s_add_u32 m0, s71, 8192
  s_add_u32 s72, s70, 8192
  buffer_load_dwordx4 v8, s[32:35], s72 offen lds
  s_add_u32 m0, s71, 12288
  s_add_u32 s72, s70, 12288
  buffer_load_dwordx4 v9, s[32:35], s72 offen lds
  s_add_u32 m0, s71, 16384
  s_add_u32 s72, s70, 16384
  buffer_load_dwordx4 v8, s[32:35], s72 offen lds
  s_nop 3
  v_cvt_pk_bf16_f32 v224, v64, v65
  v_cvt_pk_bf16_f32 v225, v66, v67
  v_cvt_pk_bf16_f32 v226, v68, v69
  v_cvt_pk_bf16_f32 v227, v70, v71
  v_cvt_pk_bf16_f32 v228, v72, v73
  v_cvt_pk_bf16_f32 v229, v74, v75
  v_cvt_pk_bf16_f32 v230, v76, v77
  v_cvt_pk_bf16_f32 v231, v78, v79
  v_cvt_pk_bf16_f32 v232, v80, v81
  v_cvt_pk_bf16_f32 v233, v82, v83
  v_cvt_pk_bf16_f32 v234, v84, v85
  v_cvt_pk_bf16_f32 v235, v86, v87
  v_cvt_pk_bf16_f32 v236, v88, v89
  v_cvt_pk_bf16_f32 v237, v90, v91
  v_cvt_pk_bf16_f32 v238, v92, v93
  v_cvt_pk_bf16_f32 v239, v94, v95
  s_cmp_lg_u32 s76, 0
  s_cbranch_scc1 L_slow_next
L_tail:
  s_add_u32 s15, s59, 262144
  s_add_u32 s15, s59, 262144
  buffer_load_dwordx4 a[128:131], v159, s[36:39], s15 offen offset:0
  buffer_load_dwordx4 a[132:135], v159, s[36:39], s15 offen offset:1024
  buffer_load_dwordx4 a[136:139], v159, s[36:39], s15 offen offset:2048
  buffer_load_dwordx4 a[140:143], v159, s[36:39], s15 offen offset:3072
  s_add_u32 s44, s10, 0x720000
  s_addc_u32 s45, s11, 0
  s_mov_b32 s46, 80000
  s_mov_b32 s47, 0x20000
  v_mul_u32_u24 v157, 21846, v114
  v_lshrrev_b32 v157, 16, v157
  v_mul_u32_u24 v158, 3, v157
  v_sub_u32 v158, v114, v158
  v_add_u32 v2, s13, v157
  v_lshlrev_b32 v2, 3, v2
  v_lshl_add_u32 v2, v158, 1, v2
  buffer_load_ushort v156, v2, s[44:47], 0 offen
  v_mfma_f32_16x16x32_bf16 v[64:67], v[240:243], v[160:163], 0
  v_bfe_u32 v0, v115, 2, 3
  v_mul_u32_u24 v0, 544, v0
  v_lshrrev_b32 v1, 5, v115
  v_lshl_add_u32 v0, v1, 3, v0
  s_lshl_b32 s70, s12, 7
  v_add_u32 v0, s70, v0
  v_and_b32 v2, 3, v115
  v_cmp_eq_u32 s[68:69], 0, v2
  v_mfma_f32_16x16x32_bf16 v[68:71], v[240:243], v[176:179], 0
  s_add_u32 s15, s59, 266240
  buffer_load_dwordx4 a[144:147], v159, s[36:39], s15 offen offset:0
  v_mul_u32_u24 v7, 4352, v2
  v_add_u32 v7, v7, v0
  v_cmp_ge_u32 vcc, 0, v2
  s_nop 1
  v_cndmask_b32_dpp v96, v176, v160, vcc quad_perm:[0,0,0,0] row_mask:0xf bank_mask:0xf
  v_cndmask_b32_dpp v97, v177, v161, vcc quad_perm:[0,0,0,0] row_mask:0xf bank_mask:0xf
  v_mfma_f32_16x16x32_bf16 v[72:75], v[240:243], v[192:195], 0
  v_cndmask_b32_dpp v98, v178, v162, vcc quad_perm:[0,0,0,0] row_mask:0xf bank_mask:0xf
  v_cndmask_b32_dpp v99, v179, v163, vcc quad_perm:[0,0,0,0] row_mask:0xf bank_mask:0xf
  v_cndmask_b32_dpp v100, v180, v164, vcc quad_perm:[0,0,0,0] row_mask:0xf bank_mask:0xf
  v_cndmask_b32_dpp v101, v181, v165, vcc quad_perm:[0,0,0,0] row_mask:0xf bank_mask:0xf
  v_mfma_f32_16x16x32_bf16 v[76:79], v[240:243], v[208:211], 0
  buffer_load_dwordx4 a[148:151], v159, s[36:39], s15 offen offset:1024
  v_cndmask_b32_dpp v102, v182, v166, vcc quad_perm:[0,0,0,0] row_mask:0xf bank_mask:0xf
  v_cndmask_b32_dpp v103, v183, v167, vcc quad_perm:[0,0,0,0] row_mask:0xf bank_mask:0xf
  v_cndmask_b32_dpp v104, v184, v168, vcc quad_perm:[0,0,0,0] row_mask:0xf bank_mask:0xf
  v_cndmask_b32_dpp v105, v185, v169, vcc quad_perm:[0,0,0,0] row_mask:0xf bank_mask:0xf
  v_mfma_f32_16x16x32_bf16 v[80:83], v[240:243], v[224:227], 0
  v_cndmask_b32_dpp v106, v186, v170, vcc quad_perm:[0,0,0,0] row_mask:0xf bank_mask:0xf
  v_cndmask_b32_dpp v107, v187, v171, vcc quad_perm:[0,0,0,0] row_mask:0xf bank_mask:0xf
  v_cndmask_b32_dpp v108, v188, v172, vcc quad_perm:[0,0,0,0] row_mask:0xf bank_mask:0xf
  v_cndmask_b32_dpp v109, v189, v173, vcc quad_perm:[0,0,0,0] row_mask:0xf bank_mask:0xf
  v_mfma_f32_16x16x32_bf16 v[64:67], v[244:247], v[164:167], v[64:67]
  buffer_load_dwordx4 a[152:155], v159, s[36:39], s15 offen offset:2048
  v_cndmask_b32_dpp v110, v190, v174, vcc quad_perm:[0,0,0,0] row_mask:0xf bank_mask:0xf
  v_cndmask_b32_dpp v111, v191, v175, vcc quad_perm:[0,0,0,0] row_mask:0xf bank_mask:0xf
  v_cmp_ge_u32 vcc, 1, v2
  s_nop 1
  v_cndmask_b32_dpp v96, v192, v96, vcc quad_perm:[0,0,0,0] row_mask:0xf bank_mask:0xf
  v_mfma_f32_16x16x32_bf16 v[68:71], v[244:247], v[180:183], v[68:71]
  v_cndmask_b32_dpp v97, v193, v97, vcc quad_perm:[0,0,0,0] row_mask:0xf bank_mask:0xf
  v_cndmask_b32_dpp v98, v194, v98, vcc quad_perm:[0,0,0,0] row_mask:0xf bank_mask:0xf
  v_cndmask_b32_dpp v99, v195, v99, vcc quad_perm:[0,0,0,0] row_mask:0xf bank_mask:0xf
  v_cndmask_b32_dpp v100, v196, v100, vcc quad_perm:[0,0,0,0] row_mask:0xf bank_mask:0xf
  v_mfma_f32_16x16x32_bf16 v[72:75], v[244:247], v[196:199], v[72:75]
  buffer_load_dwordx4 a[156:159], v159, s[36:39], s15 offen offset:3072
  v_cndmask_b32_dpp v101, v197, v101, vcc quad_perm:[0,0,0,0] row_mask:0xf bank_mask:0xf
  v_cndmask_b32_dpp v102, v198, v102, vcc quad_perm:[0,0,0,0] row_mask:0xf bank_mask:0xf
  v_cndmask_b32_dpp v103, v199, v103, vcc quad_perm:[0,0,0,0] row_mask:0xf bank_mask:0xf
  v_cndmask_b32_dpp v104, v200, v104, vcc quad_perm:[0,0,0,0] row_mask:0xf bank_mask:0xf
  v_mfma_f32_16x16x32_bf16 v[76:79], v[244:247], v[212:215], v[76:79]
  v_cndmask_b32_dpp v105, v201, v105, vcc quad_perm:[0,0,0,0] row_mask:0xf bank_mask:0xf
  v_cndmask_b32_dpp v106, v202, v106, vcc quad_perm:[0,0,0,0] row_mask:0xf bank_mask:0xf
  v_cndmask_b32_dpp v107, v203, v107, vcc quad_perm:[0,0,0,0] row_mask:0xf bank_mask:0xf
  v_cndmask_b32_dpp v108, v204, v108, vcc quad_perm:[0,0,0,0] row_mask:0xf bank_mask:0xf
  v_mfma_f32_16x16x32_bf16 v[80:83], v[244:247], v[228:231], v[80:83]
  v_cndmask_b32_dpp v109, v205, v109, vcc quad_perm:[0,0,0,0] row_mask:0xf bank_mask:0xf
  v_cndmask_b32_dpp v110, v206, v110, vcc quad_perm:[0,0,0,0] row_mask:0xf bank_mask:0xf
  v_cndmask_b32_dpp v111, v207, v111, vcc quad_perm:[0,0,0,0] row_mask:0xf bank_mask:0xf
  v_cmp_ge_u32 vcc, 2, v2
  s_nop 1
  v_mfma_f32_16x16x32_bf16 v[64:67], v[248:251], v[168:171], v[64:67]
  v_cndmask_b32_dpp v96, v208, v96, vcc quad_perm:[0,0,0,0] row_mask:0xf bank_mask:0xf
  v_cndmask_b32_dpp v97, v209, v97, vcc quad_perm:[0,0,0,0] row_mask:0xf bank_mask:0xf
  v_cndmask_b32_dpp v98, v210, v98, vcc quad_perm:[0,0,0,0] row_mask:0xf bank_mask:0xf
  v_cndmask_b32_dpp v99, v211, v99, vcc quad_perm:[0,0,0,0] row_mask:0xf bank_mask:0xf
  v_mfma_f32_16x16x32_bf16 v[68:71], v[248:251], v[184:187], v[68:71]
  v_cndmask_b32_dpp v100, v212, v100, vcc quad_perm:[0,0,0,0] row_mask:0xf bank_mask:0xf
  v_cndmask_b32_dpp v101, v213, v101, vcc quad_perm:[0,0,0,0] row_mask:0xf bank_mask:0xf
  v_cndmask_b32_dpp v102, v214, v102, vcc quad_perm:[0,0,0,0] row_mask:0xf bank_mask:0xf
  v_cndmask_b32_dpp v103, v215, v103, vcc quad_perm:[0,0,0,0] row_mask:0xf bank_mask:0xf
  v_mfma_f32_16x16x32_bf16 v[72:75], v[248:251], v[200:203], v[72:75]
  v_cndmask_b32_dpp v104, v216, v104, vcc quad_perm:[0,0,0,0] row_mask:0xf bank_mask:0xf
  v_cndmask_b32_dpp v105, v217, v105, vcc quad_perm:[0,0,0,0] row_mask:0xf bank_mask:0xf
  v_cndmask_b32_dpp v106, v218, v106, vcc quad_perm:[0,0,0,0] row_mask:0xf bank_mask:0xf
  v_cndmask_b32_dpp v107, v219, v107, vcc quad_perm:[0,0,0,0] row_mask:0xf bank_mask:0xf
  v_mfma_f32_16x16x32_bf16 v[76:79], v[248:251], v[216:219], v[76:79]
  v_cndmask_b32_dpp v108, v220, v108, vcc quad_perm:[0,0,0,0] row_mask:0xf bank_mask:0xf
  v_cndmask_b32_dpp v109, v221, v109, vcc quad_perm:[0,0,0,0] row_mask:0xf bank_mask:0xf
  v_cndmask_b32_dpp v110, v222, v110, vcc quad_perm:[0,0,0,0] row_mask:0xf bank_mask:0xf
  v_cndmask_b32_dpp v111, v223, v111, vcc quad_perm:[0,0,0,0] row_mask:0xf bank_mask:0xf
  v_mfma_f32_16x16x32_bf16 v[80:83], v[248:251], v[232:235], v[80:83]
  v_and_b32 v122, 15, v115
  v_lshrrev_b32 v121, 4, v115
  v_xor_b32 v121, v121, v122
  v_lshlrev_b32 v120, 9, v122
  v_mfma_f32_16x16x32_bf16 v[64:67], v[252:255], v[172:175], v[64:67]
  v_add_u32 v120, 65536, v120
  v_xor_b32 v123, 0, v121
  v_lshl_add_u32 v116, v123, 4, v120
  v_xor_b32 v123, 4, v121
  v_mfma_f32_16x16x32_bf16 v[68:71], v[252:255], v[188:191], v[68:71]
  v_lshl_add_u32 v117, v123, 4, v120
  v_xor_b32 v123, 8, v121
  v_lshl_add_u32 v118, v123, 4, v120
  v_xor_b32 v123, 12, v121
  v_mfma_f32_16x16x32_bf16 v[72:75], v[252:255], v[204:207], v[72:75]
  v_lshl_add_u32 v119, v123, 4, v120
  v_and_b32 v4, 15, v115
  v_mul_u32_u24 v4, 544, v4
  v_lshrrev_b32 v5, 4, v115
  v_mfma_f32_16x16x32_bf16 v[76:79], v[252:255], v[220:223], v[76:79]
  v_lshl_add_u32 v4, v5, 4, v4
  v_lshlrev_b32 v6, 2, v115
  s_mul_i32 s70, s12, 1280
  v_add_u32 v6, s70, v6
  v_mfma_f32_16x16x32_bf16 v[80:83], v[252:255], v[236:239], v[80:83]
  s_waitcnt vmcnt(9)
  s_barrier
  ds_read_b128 a[176:179], v116 offset:0
  ds_read_b128 a[180:183], v116 offset:8192
  ds_read_b128 a[184:187], v116 offset:16384
  s_waitcnt lgkmcnt(0)
  ds_read_b128 a[188:191], v117 offset:0
  ds_read_b128 a[192:195], v117 offset:8192
  ds_read_b128 a[196:199], v117 offset:16384
  v_mfma_f32_16x16x32_bf16 v[8:11], a[0:3], a[176:179], 0
  s_add_u32 s15, s59, 270336
  buffer_load_dwordx4 a[160:163], v159, s[36:39], s15 offen offset:0
  v_mfma_f32_16x16x32_bf16 v[12:15], a[4:7], a[176:179], 0
  v_and_b32 v132, 15, v115
  v_lshrrev_b32 v133, 5, v115
  v_mfma_f32_16x16x32_bf16 v[16:19], a[8:11], a[176:179], 0
  s_lshl_b32 s70, s12, 3
  v_add_u32 v133, s70, v133
  s_mov_b64 exec, s[68:69]
  ds_write_b64 v0, v[224:225] offset:17408
  ds_write_b64 v0, v[226:227] offset:17424
  ds_write_b64 v0, v[228:229] offset:17440
  ds_write_b64 v0, v[230:231] offset:17456
  s_mov_b64 exec, -1
  v_mfma_f32_16x16x32_bf16 v[20:23], a[12:15], a[176:179], 0
  buffer_load_dwordx4 a[164:167], v159, s[36:39], s15 offen offset:1024
  v_mfma_f32_16x16x32_bf16 v[24:27], a[0:3], a[180:183], 0
  v_bfe_u32 v134, v115, 4, 1
  v_lshlrev_b32 v134, 3, v134
  v_mfma_f32_16x16x32_bf16 v[28:31], a[4:7], a[180:183], 0
  v_lshl_add_u32 v134, v132, 9, v134
  v_add_u32 v134, 65536, v134
  v_mfma_f32_16x16x32_bf16 v[32:35], a[8:11], a[180:183], 0
  buffer_load_dwordx4 a[168:171], v159, s[36:39], s15 offen offset:2048
  s_mov_b64 exec, s[68:69]
  ds_write_b64 v0, v[232:233] offset:17472
  ds_write_b64 v0, v[234:235] offset:17488
  ds_write_b64 v0, v[236:237] offset:17504
  ds_write_b64 v0, v[238:239] offset:17520
  s_mov_b64 exec, -1
  v_mfma_f32_16x16x32_bf16 v[36:39], a[12:15], a[180:183], 0
  v_add_u32 v135, 0, v133
  v_xor_b32 v135, v135, v132
  v_mfma_f32_16x16x32_bf16 v[40:43], a[0:3], a[184:187], 0
  v_lshl_add_u32 v136, v135, 4, v134
  v_add_u32 v135, 2, v133
  v_mfma_f32_16x16x32_bf16 v[44:47], a[4:7], a[184:187], 0
  buffer_load_dwordx4 a[172:175], v159, s[36:39], s15 offen offset:3072
  v_mfma_f32_16x16x32_bf16 v[48:51], a[8:11], a[184:187], 0
  v_xor_b32 v135, v135, v132
  v_lshl_add_u32 v137, v135, 4, v134
  ds_write_b64 v7, v[96:97] offset:0
  v_mfma_f32_16x16x32_bf16 v[52:55], a[12:15], a[184:187], 0
  v_add_u32 v135, 4, v133
  v_xor_b32 v135, v135, v132
  s_waitcnt lgkmcnt(9)
  ds_read_b128 a[176:179], v118 offset:0
  ds_read_b128 a[180:183], v118 offset:8192
  ds_read_b128 a[184:187], v118 offset:16384
  v_mfma_f32_16x16x32_bf16 v[8:11], a[16:19], a[188:191], v[8:11]
  s_add_u32 s15, s59, 274432
  buffer_load_dwordx4 a[216:219], v159, s[36:39], s15 offen offset:0
  v_mfma_f32_16x16x32_bf16 v[12:15], a[20:23], a[188:191], v[12:15]
  v_lshl_add_u32 v138, v135, 4, v134
  v_add_u32 v135, 6, v133
  v_mfma_f32_16x16x32_bf16 v[16:19], a[24:27], a[188:191], v[16:19]
  v_xor_b32 v135, v135, v132
  v_lshl_add_u32 v139, v135, 4, v134
  ds_write_b64 v7, v[98:99] offset:16
  v_mfma_f32_16x16x32_bf16 v[20:23], a[28:31], a[188:191], v[20:23]
  buffer_load_dwordx4 a[220:223], v159, s[36:39], s15 offen offset:1024
  v_mfma_f32_16x16x32_bf16 v[24:27], a[16:19], a[192:195], v[24:27]
  v_lshrrev_b32 v124, 3, v157
  v_min_u32 v124, 4, v124
  v_mfma_f32_16x16x32_bf16 v[28:31], a[20:23], a[192:195], v[28:31]
  v_and_b32 v125, 7, v157
  v_lshlrev_b32 v125, 2, v125
  v_mfma_f32_16x16x32_bf16 v[32:35], a[24:27], a[192:195], v[32:35]
  buffer_load_dwordx4 a[224:227], v159, s[36:39], s15 offen offset:2048
  ds_write_b64 v7, v[100:101] offset:32
  v_mfma_f32_16x16x32_bf16 v[36:39], a[28:31], a[192:195], v[36:39]
  v_add3_u32 v125, v125, v158, 1
  v_lshlrev_b32 v125, 2, v125
  v_mfma_f32_16x16x32_bf16 v[40:43], a[16:19], a[196:199], v[40:43]
  v_lshl_add_u32 v125, v124, 8, v125
  v_add_u32 v125, 26624, v125
  v_mfma_f32_16x16x32_bf16 v[44:47], a[20:23], a[196:199], v[44:47]
  buffer_load_dwordx4 a[228:231], v159, s[36:39], s15 offen offset:3072
  v_mfma_f32_16x16x32_bf16 v[48:51], a[24:27], a[196:199], v[48:51]
  v_lshlrev_b32 v124, 1, v114
  s_mul_i32 s70, s2, 240
  ds_write_b64 v7, v[102:103] offset:48
  v_mfma_f32_16x16x32_bf16 v[52:55], a[28:31], a[196:199], v[52:55]
  s_add_u32 s70, s70, 5120000
  s_add_u32 s20, s8, s70
  s_addc_u32 s21, s9, 0
  s_mov_b32 s22, 240
  s_mov_b32 s23, 0x20000
  s_waitcnt lgkmcnt(3)
  ds_read_b128 a[188:191], v119 offset:0
  ds_read_b128 a[192:195], v119 offset:8192
  ds_read_b128 a[196:199], v119 offset:16384
  v_mfma_f32_16x16x32_bf16 v[8:11], a[32:35], a[176:179], v[8:11]
  s_add_u32 s15, s59, 278528
  buffer_load_dwordx4 a[232:235], v159, s[36:39], s15 offen offset:0
  v_mfma_f32_16x16x32_bf16 v[12:15], a[36:39], a[176:179], v[12:15]
  s_mul_i32 s70, s2, 20480
  s_add_u32 s40, s8, s70
  s_addc_u32 s41, s9, 0
  s_mov_b32 s42, 20480
  s_mov_b32 s43, 0x20000
  v_mfma_f32_16x16x32_bf16 v[16:19], a[40:43], a[176:179], v[16:19]
  v_and_b32 v140, 15, v115
  v_lshrrev_b32 v141, 4, v115
  ds_write_b64 v7, v[104:105] offset:64
  v_mfma_f32_16x16x32_bf16 v[20:23], a[44:47], a[176:179], v[20:23]
  buffer_load_dwordx4 a[236:239], v159, s[36:39], s15 offen offset:1024
  v_mfma_f32_16x16x32_bf16 v[24:27], a[32:35], a[180:183], v[24:27]
  v_and_b32 v142, 1, v141
  v_lshlrev_b32 v142, 5, v142
  v_mfma_f32_16x16x32_bf16 v[28:31], a[36:39], a[180:183], v[28:31]
  v_lshrrev_b32 v141, 1, v141
  v_lshl_add_u32 v142, v141, 4, v142
  v_mfma_f32_16x16x32_bf16 v[32:35], a[40:43], a[180:183], v[32:35]
  buffer_load_dwordx4 a[240:243], v159, s[36:39], s15 offen offset:2048
  ds_write_b64 v7, v[106:107] offset:80
  v_mfma_f32_16x16x32_bf16 v[36:39], a[44:47], a[180:183], v[36:39]
  v_lshl_add_u32 v140, v140, 9, v142
  s_lshl_b32 s70, s12, 7
  v_mfma_f32_16x16x32_bf16 v[40:43], a[32:35], a[184:187], v[40:43]
  v_add_u32 v140, s70, v140
  s_mov_b32 s78, 0xbfb8aa3b
  v_mfma_f32_16x16x32_bf16 v[44:47], a[36:39], a[184:187], v[44:47]
  buffer_load_dwordx4 a[244:247], v159, s[36:39], s15 offen offset:3072
  v_mfma_f32_16x16x32_bf16 v[48:51], a[40:43], a[184:187], v[48:51]
  s_mov_b32 s79, s78
  s_mov_b32 s80, 0xbf317218
  ds_write_b64 v7, v[108:109] offset:96
  v_mfma_f32_16x16x32_bf16 v[52:55], a[44:47], a[184:187], v[52:55]
  s_waitcnt lgkmcnt(3)
  ds_read_b128 a[176:179], v116 offset:256
  ds_read_b128 a[180:183], v116 offset:8448
  ds_read_b128 a[184:187], v116 offset:16640
  v_mfma_f32_16x16x32_bf16 v[8:11], a[48:51], a[188:191], v[8:11]
  s_add_u32 s15, s59, 282624
  buffer_load_dwordx4 a[248:251], v159, s[36:39], s15 offen offset:0
  v_mfma_f32_16x16x32_bf16 v[12:15], a[52:55], a[188:191], v[12:15]
  v_mfma_f32_16x16x32_bf16 v[16:19], a[56:59], a[188:191], v[16:19]
  ds_write_b64 v7, v[110:111] offset:112
  v_mfma_f32_16x16x32_bf16 v[20:23], a[60:63], a[188:191], v[20:23]
  buffer_load_dwordx4 a[252:255], v159, s[36:39], s15 offen offset:1024
  v_mfma_f32_16x16x32_bf16 v[24:27], a[48:51], a[192:195], v[24:27]
  v_mfma_f32_16x16x32_bf16 v[28:31], a[52:55], a[192:195], v[28:31]
  v_mfma_f32_16x16x32_bf16 v[32:35], a[56:59], a[192:195], v[32:35]
  buffer_load_dwordx4 a[0:3], v159, s[36:39], s15 offen offset:2048
  ds_write_b32 v6, v64 offset:26624
  v_mfma_f32_16x16x32_bf16 v[36:39], a[60:63], a[192:195], v[36:39]
  v_mfma_f32_16x16x32_bf16 v[40:43], a[48:51], a[196:199], v[40:43]
  v_mfma_f32_16x16x32_bf16 v[44:47], a[52:55], a[196:199], v[44:47]
  buffer_load_dwordx4 a[4:7], v159, s[36:39], s15 offen offset:3072
  v_mfma_f32_16x16x32_bf16 v[48:51], a[56:59], a[196:199], v[48:51]
  ds_write_b32 v6, v68 offset:26880
  v_mfma_f32_16x16x32_bf16 v[52:55], a[60:63], a[196:199], v[52:55]
  s_waitcnt lgkmcnt(3)
  ds_read_b128 a[188:191], v117 offset:256
  ds_read_b128 a[192:195], v117 offset:8448
  ds_read_b128 a[196:199], v117 offset:16640
  v_mfma_f32_16x16x32_bf16 v[8:11], a[64:67], a[176:179], v[8:11]
  s_add_u32 s15, s59, 286720
  buffer_load_dwordx4 a[8:11], v159, s[36:39], s15 offen offset:0
  v_mfma_f32_16x16x32_bf16 v[12:15], a[68:71], a[176:179], v[12:15]
  v_mfma_f32_16x16x32_bf16 v[16:19], a[72:75], a[176:179], v[16:19]
  ds_write_b32 v6, v72 offset:27136
  v_mfma_f32_16x16x32_bf16 v[20:23], a[76:79], a[176:179], v[20:23]
  buffer_load_dwordx4 a[12:15], v159, s[36:39], s15 offen offset:1024
  v_mfma_f32_16x16x32_bf16 v[24:27], a[64:67], a[180:183], v[24:27]
  v_mfma_f32_16x16x32_bf16 v[28:31], a[68:71], a[180:183], v[28:31]
  v_mfma_f32_16x16x32_bf16 v[32:35], a[72:75], a[180:183], v[32:35]
  buffer_load_dwordx4 a[16:19], v159, s[36:39], s15 offen offset:2048
  ds_write_b32 v6, v76 offset:27392
  v_mfma_f32_16x16x32_bf16 v[36:39], a[76:79], a[180:183], v[36:39]
  v_mfma_f32_16x16x32_bf16 v[40:43], a[64:67], a[184:187], v[40:43]
  v_mfma_f32_16x16x32_bf16 v[44:47], a[68:71], a[184:187], v[44:47]
  buffer_load_dwordx4 a[20:23], v159, s[36:39], s15 offen offset:3072
  v_mfma_f32_16x16x32_bf16 v[48:51], a[72:75], a[184:187], v[48:51]
  ds_write_b32 v6, v80 offset:27648
  v_mfma_f32_16x16x32_bf16 v[52:55], a[76:79], a[184:187], v[52:55]
  s_waitcnt lgkmcnt(3)
  ds_read_b128 a[176:179], v118 offset:256
  ds_read_b128 a[180:183], v118 offset:8448
  ds_read_b128 a[184:187], v118 offset:16640
  v_mfma_f32_16x16x32_bf16 v[8:11], a[80:83], a[188:191], v[8:11]
  s_add_u32 s15, s59, 290816
  buffer_load_dwordx4 a[24:27], v159, s[36:39], s15 offen offset:0
  v_mfma_f32_16x16x32_bf16 v[12:15], a[84:87], a[188:191], v[12:15]
  v_mfma_f32_16x16x32_bf16 v[16:19], a[88:91], a[188:191], v[16:19]
  v_mfma_f32_16x16x32_bf16 v[20:23], a[92:95], a[188:191], v[20:23]
  buffer_load_dwordx4 a[28:31], v159, s[36:39], s15 offen offset:1024
  v_mfma_f32_16x16x32_bf16 v[24:27], a[80:83], a[192:195], v[24:27]
  v_mfma_f32_16x16x32_bf16 v[28:31], a[84:87], a[192:195], v[28:31]
  v_mfma_f32_16x16x32_bf16 v[32:35], a[88:91], a[192:195], v[32:35]
  buffer_load_dwordx4 a[32:35], v159, s[36:39], s15 offen offset:2048
  v_mfma_f32_16x16x32_bf16 v[36:39], a[92:95], a[192:195], v[36:39]
  v_mfma_f32_16x16x32_bf16 v[40:43], a[80:83], a[196:199], v[40:43]
  v_mfma_f32_16x16x32_bf16 v[44:47], a[84:87], a[196:199], v[44:47]
  buffer_load_dwordx4 a[36:39], v159, s[36:39], s15 offen offset:3072
  v_mfma_f32_16x16x32_bf16 v[48:51], a[88:91], a[196:199], v[48:51]
  v_mfma_f32_16x16x32_bf16 v[52:55], a[92:95], a[196:199], v[52:55]
  s_waitcnt lgkmcnt(0)
  s_barrier
  ds_read_b128 a[188:191], v119 offset:256
  ds_read_b128 a[192:195], v119 offset:8448
  ds_read_b128 a[196:199], v119 offset:16640
  v_mfma_f32_16x16x32_bf16 v[8:11], a[96:99], a[176:179], v[8:11]
  v_mfma_f32_16x16x32_bf16 v[12:15], a[100:103], a[176:179], v[12:15]
  v_mfma_f32_16x16x32_bf16 v[16:19], a[104:107], a[176:179], v[16:19]
  v_mfma_f32_16x16x32_bf16 v[20:23], a[108:111], a[176:179], v[20:23]
  v_mfma_f32_16x16x32_bf16 v[24:27], a[96:99], a[180:183], v[24:27]
  v_mfma_f32_16x16x32_bf16 v[28:31], a[100:103], a[180:183], v[28:31]
  v_mfma_f32_16x16x32_bf16 v[32:35], a[104:107], a[180:183], v[32:35]
  v_mfma_f32_16x16x32_bf16 v[36:39], a[108:111], a[180:183], v[36:39]
  v_mfma_f32_16x16x32_bf16 v[40:43], a[96:99], a[184:187], v[40:43]
  v_mfma_f32_16x16x32_bf16 v[44:47], a[100:103], a[184:187], v[44:47]
  v_mfma_f32_16x16x32_bf16 v[48:51], a[104:107], a[184:187], v[48:51]
  v_mfma_f32_16x16x32_bf16 v[52:55], a[108:111], a[184:187], v[52:55]
  s_waitcnt lgkmcnt(0)
  v_mfma_f32_16x16x32_bf16 v[8:11], a[112:115], a[188:191], v[8:11]
  ds_read_b128 a[40:43], v4 offset:0
  v_mfma_f32_16x16x32_bf16 v[12:15], a[116:119], a[188:191], v[12:15]
  ds_read_b128 a[44:47], v4 offset:64
  v_mfma_f32_16x16x32_bf16 v[16:19], a[120:123], a[188:191], v[16:19]
  ds_read_b128 a[48:51], v4 offset:128
  v_mfma_f32_16x16x32_bf16 v[20:23], a[124:127], a[188:191], v[20:23]
  ds_read_b128 a[52:55], v4 offset:192
  v_mfma_f32_16x16x32_bf16 v[24:27], a[112:115], a[192:195], v[24:27]
  ds_read_b128 a[56:59], v4 offset:256
  v_mfma_f32_16x16x32_bf16 v[28:31], a[116:119], a[192:195], v[28:31]
  ds_read_b128 a[60:63], v4 offset:320
  v_mfma_f32_16x16x32_bf16 v[32:35], a[120:123], a[192:195], v[32:35]
  ds_read_b128 a[64:67], v4 offset:384
  v_mfma_f32_16x16x32_bf16 v[36:39], a[124:127], a[192:195], v[36:39]
  ds_read_b128 a[68:71], v4 offset:448
  v_mfma_f32_16x16x32_bf16 v[40:43], a[112:115], a[196:199], v[40:43]
  v_mul_f32 v8, s78, v8
  v_mul_f32 v9, s78, v9
  v_mul_f32 v10, s78, v10
  v_mul_f32 v11, s78, v11
  v_mfma_f32_16x16x32_bf16 v[44:47], a[116:119], a[196:199], v[44:47]
  v_mul_f32 v12, s78, v12
  v_mul_f32 v13, s78, v13
  v_mul_f32 v14, s78, v14
  v_mul_f32 v15, s78, v15
  v_mfma_f32_16x16x32_bf16 v[48:51], a[120:123], a[196:199], v[48:51]
  v_mul_f32 v16, s78, v16
  v_mul_f32 v17, s78, v17
  v_mul_f32 v18, s78, v18
  v_mul_f32 v19, s78, v19
  v_mfma_f32_16x16x32_bf16 v[52:55], a[124:127], a[196:199], v[52:55]
  v_mul_f32 v20, s78, v20
  v_mul_f32 v21, s78, v21
  v_mul_f32 v22, s78, v22
  v_mul_f32 v23, s78, v23
  s_waitcnt vmcnt(29) lgkmcnt(7)
  v_mfma_f32_16x16x32_bf16 v[8:11], a[128:131], a[40:43], v[8:11]
  ds_read_b128 a[72:75], v4 offset:8704
  ds_read_b128 a[76:79], v4 offset:8768
  v_mfma_f32_16x16x32_bf16 v[12:15], a[132:135], a[40:43], v[12:15]
  ds_read_b128 a[80:83], v4 offset:8832
  ds_read_b128 a[84:87], v4 offset:8896
  v_mfma_f32_16x16x32_bf16 v[16:19], a[136:139], a[40:43], v[16:19]
  ds_read_b128 a[88:91], v4 offset:8960
  v_mfma_f32_16x16x32_bf16 v[20:23], a[140:143], a[40:43], v[20:23]
  ds_read_b128 a[92:95], v4 offset:9024
  ds_read_b128 a[96:99], v4 offset:9088
  s_waitcnt vmcnt(24) lgkmcnt(13)
  v_mfma_f32_16x16x32_bf16 v[8:11], a[144:147], a[44:47], v[8:11]
  ds_read_b128 a[100:103], v4 offset:9152
  v_mfma_f32_16x16x32_bf16 v[12:15], a[148:151], a[44:47], v[12:15]
  v_mul_f32 v24, s78, v24
  v_mul_f32 v25, s78, v25
  v_mfma_f32_16x16x32_bf16 v[16:19], a[152:155], a[44:47], v[16:19]
  v_mul_f32 v26, s78, v26
  v_mfma_f32_16x16x32_bf16 v[20:23], a[156:159], a[44:47], v[20:23]
  v_mul_f32 v27, s78, v27
  v_mul_f32 v28, s78, v28
  s_waitcnt vmcnt(20) lgkmcnt(13)
  v_mfma_f32_16x16x32_bf16 v[8:11], a[160:163], a[48:51], v[8:11]
  v_mul_f32 v29, s78, v29
  v_mfma_f32_16x16x32_bf16 v[12:15], a[164:167], a[48:51], v[12:15]
  v_mul_f32 v30, s78, v30
  v_mul_f32 v31, s78, v31
  v_mfma_f32_16x16x32_bf16 v[16:19], a[168:171], a[48:51], v[16:19]
  v_mul_f32 v32, s78, v32
  v_mfma_f32_16x16x32_bf16 v[20:23], a[172:175], a[48:51], v[20:23]
  v_mul_f32 v33, s78, v33
  v_mul_f32 v34, s78, v34
  s_waitcnt vmcnt(16) lgkmcnt(12)
  v_mfma_f32_16x16x32_bf16 v[8:11], a[216:219], a[52:55], v[8:11]
  v_mul_f32 v35, s78, v35
  v_mfma_f32_16x16x32_bf16 v[12:15], a[220:223], a[52:55], v[12:15]
  v_mul_f32 v36, s78, v36
  v_mul_f32 v37, s78, v37
  v_mfma_f32_16x16x32_bf16 v[16:19], a[224:227], a[52:55], v[16:19]
  v_mul_f32 v38, s78, v38
  v_mfma_f32_16x16x32_bf16 v[20:23], a[228:231], a[52:55], v[20:23]
  v_mul_f32 v39, s78, v39
  ds_read_b32 v126, v125 offset:0
  s_waitcnt vmcnt(12) lgkmcnt(12)
  v_mfma_f32_16x16x32_bf16 v[8:11], a[232:235], a[56:59], v[8:11]
  ds_read_b32 v127, v125 offset:1280
  ds_read_b32 v128, v125 offset:2560
  v_mfma_f32_16x16x32_bf16 v[12:15], a[236:239], a[56:59], v[12:15]
  ds_read_b32 v129, v125 offset:3840
  v_mfma_f32_16x16x32_bf16 v[16:19], a[240:243], a[56:59], v[16:19]
  ds_read_b64 v[208:209], v136 offset:0
  ds_read_b64 v[210:211], v137 offset:0
  v_mfma_f32_16x16x32_bf16 v[20:23], a[244:247], a[56:59], v[20:23]
  ds_read_b64 v[212:213], v138 offset:0
  s_waitcnt vmcnt(8) lgkmcnt(15)
  v_mfma_f32_16x16x32_bf16 v[8:11], a[248:251], a[60:63], v[8:11]
  ds_read_b64 v[214:215], v139 offset:0
  ds_read_b64 v[216:217], v136 offset:8192
  v_mfma_f32_16x16x32_bf16 v[12:15], a[252:255], a[60:63], v[12:15]
  ds_read_b64 v[218:219], v137 offset:8192
  v_mfma_f32_16x16x32_bf16 v[16:19], a[0:3], a[60:63], v[16:19]
  ds_read_b64 v[220:221], v138 offset:8192
  ds_read_b64 v[222:223], v139 offset:8192
  v_mfma_f32_16x16x32_bf16 v[20:23], a[4:7], a[60:63], v[20:23]
  ds_read_b64 v[224:225], v136 offset:16384
  s_waitcnt vmcnt(4)
  v_mfma_f32_16x16x32_bf16 v[8:11], a[8:11], a[64:67], v[8:11]
  ds_read_b64 v[226:227], v137 offset:16384
  ds_read_b64 v[228:229], v138 offset:16384
  v_mfma_f32_16x16x32_bf16 v[12:15], a[12:15], a[64:67], v[12:15]
  ds_read_b64 v[230:231], v139 offset:16384
  v_mfma_f32_16x16x32_bf16 v[16:19], a[16:19], a[64:67], v[16:19]
  s_waitcnt lgkmcnt(12)
  v_add_f32 v126, v126, v127
  v_mfma_f32_16x16x32_bf16 v[20:23], a[20:23], a[64:67], v[20:23]
  v_add_f32 v126, v126, v128
  s_waitcnt vmcnt(0)
  v_mfma_f32_16x16x32_bf16 v[8:11], a[24:27], a[68:71], v[8:11]
  v_add_f32 v126, v126, v129
  v_mfma_f32_16x16x32_bf16 v[12:15], a[28:31], a[68:71], v[12:15]
  v_lshlrev_b32 v123, 16, v156
  v_mfma_f32_16x16x32_bf16 v[16:19], a[32:35], a[68:71], v[16:19]
  v_fmac_f32 v123, s80, v126
  v_cvt_pk_bf16_f32 v123, v123, v123
  v_mfma_f32_16x16x32_bf16 v[20:23], a[36:39], a[68:71], v[20:23]
  buffer_store_short v123, v124, s[20:23], 0 offen sc1
  v_mfma_f32_16x16x32_bf16 v[24:27], a[128:131], a[72:75], v[24:27]
  ds_read_b128 a[176:179], v4 offset:17408
  ds_read_b128 a[180:183], v4 offset:17472
  ds_read_b128 a[184:187], v4 offset:17536
  ds_read_b128 a[188:191], v4 offset:17600
  v_mfma_f32_16x16x32_bf16 v[28:31], a[132:135], a[72:75], v[28:31]
  ds_read_b128 a[192:195], v4 offset:17664
  ds_read_b128 a[196:199], v4 offset:17728
  ds_read_b128 a[200:203], v4 offset:17792
  ds_read_b128 a[204:207], v4 offset:17856
  v_mfma_f32_16x16x32_bf16 v[32:35], a[136:139], a[72:75], v[32:35]
  v_mul_f32 v40, s78, v40
  v_mul_f32 v41, s78, v41
  v_mul_f32 v42, s78, v42
  v_mul_f32 v43, s78, v43
  v_mfma_f32_16x16x32_bf16 v[36:39], a[140:143], a[72:75], v[36:39]
  v_mul_f32 v44, s78, v44
  v_mul_f32 v45, s78, v45
  v_mul_f32 v46, s78, v46
  v_mfma_f32_16x16x32_bf16 v[24:27], a[144:147], a[76:79], v[24:27]
  v_mul_f32 v47, s78, v47
  v_mul_f32 v48, s78, v48
  v_mul_f32 v49, s78, v49
  v_mul_f32 v50, s78, v50
  v_mfma_f32_16x16x32_bf16 v[28:31], a[148:151], a[76:79], v[28:31]
  v_mul_f32 v51, s78, v51
  v_mul_f32 v52, s78, v52
  v_mul_f32 v53, s78, v53
  v_mul_f32 v54, s78, v54
  v_mfma_f32_16x16x32_bf16 v[32:35], a[152:155], a[76:79], v[32:35]
  v_mul_f32 v55, s78, v55
  s_waitcnt lgkmcnt(15)
  v_lshlrev_b32 v64, 16, v208
  v_and_b32 v65, s77, v208
  v_mfma_f32_16x16x32_bf16 v[36:39], a[156:159], a[76:79], v[36:39]
  v_lshlrev_b32 v66, 16, v209
  v_and_b32 v67, s77, v209
  v_exp_f32 v56, v8
  v_mfma_f32_16x16x32_bf16 v[24:27], a[160:163], a[80:83], v[24:27]
  v_exp_f32 v57, v9
  v_exp_f32 v58, v10
  v_exp_f32 v59, v11
  v_fma_f32 v56, v56, s78, s78
  v_mfma_f32_16x16x32_bf16 v[28:31], a[164:167], a[80:83], v[28:31]
  v_fma_f32 v57, v57, s78, s78
  v_fma_f32 v58, v58, s78, s78
  v_fma_f32 v59, v59, s78, s78
  v_rcp_f32 v56, v56
  v_mfma_f32_16x16x32_bf16 v[32:35], a[168:171], a[80:83], v[32:35]
  v_rcp_f32 v57, v57
  v_rcp_f32 v58, v58
  v_rcp_f32 v59, v59
  v_fma_f32 v56, v56, v8, v64
  v_mfma_f32_16x16x32_bf16 v[36:39], a[172:175], a[80:83], v[36:39]
  v_fma_f32 v57, v57, v9, v65
  v_fma_f32 v58, v58, v10, v66
  v_fma_f32 v59, v59, v11, v67
  v_mfma_f32_16x16x32_bf16 v[24:27], a[216:219], a[84:87], v[24:27]
  v_cvt_pk_bf16_f32 v96, v56, v57
  v_cvt_pk_bf16_f32 v97, v58, v59
  v_lshlrev_b32 v68, 16, v210
  v_mfma_f32_16x16x32_bf16 v[28:31], a[220:223], a[84:87], v[28:31]
  v_and_b32 v69, s77, v210
  v_lshlrev_b32 v70, 16, v211
  v_and_b32 v71, s77, v211
  v_exp_f32 v60, v12
  v_mfma_f32_16x16x32_bf16 v[32:35], a[224:227], a[84:87], v[32:35]
  v_exp_f32 v61, v13
  v_exp_f32 v62, v14
  v_exp_f32 v63, v15
  v_fma_f32 v60, v60, s78, s78
  v_mfma_f32_16x16x32_bf16 v[36:39], a[228:231], a[84:87], v[36:39]
  v_fma_f32 v61, v61, s78, s78
  v_fma_f32 v62, v62, s78, s78
  v_fma_f32 v63, v63, s78, s78
  v_mfma_f32_16x16x32_bf16 v[24:27], a[232:235], a[88:91], v[24:27]
  v_rcp_f32 v60, v60
  v_rcp_f32 v61, v61
  v_rcp_f32 v62, v62
  v_rcp_f32 v63, v63
  v_mfma_f32_16x16x32_bf16 v[28:31], a[236:239], a[88:91], v[28:31]
  v_fma_f32 v60, v60, v12, v68
  v_fma_f32 v61, v61, v13, v69
  v_fma_f32 v62, v62, v14, v70
  v_fma_f32 v63, v63, v15, v71
  v_mfma_f32_16x16x32_bf16 v[32:35], a[240:243], a[88:91], v[32:35]
  v_cvt_pk_bf16_f32 v98, v60, v61
  v_cvt_pk_bf16_f32 v99, v62, v63
  s_nop 1
  v_permlane16_swap_b32 v96, v98
  v_permlane16_swap_b32 v97, v99
  s_movk_i32 s72, 0
  buffer_store_dwordx4 v[96:99], v140, s[40:43], s72 offen offset:0 sc1
  v_mfma_f32_16x16x32_bf16 v[36:39], a[244:247], a[88:91], v[36:39]
  v_lshlrev_b32 v64, 16, v212
  v_and_b32 v65, s77, v212
  v_mfma_f32_16x16x32_bf16 v[24:27], a[248:251], a[92:95], v[24:27]
  v_lshlrev_b32 v66, 16, v213
  v_and_b32 v67, s77, v213
  v_exp_f32 v56, v16
  v_exp_f32 v57, v17
  v_mfma_f32_16x16x32_bf16 v[28:31], a[252:255], a[92:95], v[28:31]
  v_exp_f32 v58, v18
  v_exp_f32 v59, v19
  v_fma_f32 v56, v56, s78, s78
  v_fma_f32 v57, v57, s78, s78
  v_mfma_f32_16x16x32_bf16 v[32:35], a[0:3], a[92:95], v[32:35]
  v_fma_f32 v58, v58, s78, s78
  v_fma_f32 v59, v59, s78, s78
  v_rcp_f32 v56, v56
  v_rcp_f32 v57, v57
  v_mfma_f32_16x16x32_bf16 v[36:39], a[4:7], a[92:95], v[36:39]
  v_rcp_f32 v58, v58
  v_rcp_f32 v59, v59
  v_fma_f32 v56, v56, v16, v64
  v_mfma_f32_16x16x32_bf16 v[24:27], a[8:11], a[96:99], v[24:27]
  v_fma_f32 v57, v57, v17, v65
  v_fma_f32 v58, v58, v18, v66
  v_fma_f32 v59, v59, v19, v67
  v_cvt_pk_bf16_f32 v100, v56, v57
  v_mfma_f32_16x16x32_bf16 v[28:31], a[12:15], a[96:99], v[28:31]
  v_cvt_pk_bf16_f32 v101, v58, v59
  v_lshlrev_b32 v68, 16, v214
  v_and_b32 v69, s77, v214
  v_mfma_f32_16x16x32_bf16 v[32:35], a[16:19], a[96:99], v[32:35]
  v_lshlrev_b32 v70, 16, v215
  v_and_b32 v71, s77, v215
  v_exp_f32 v60, v20
  v_exp_f32 v61, v21
  v_mfma_f32_16x16x32_bf16 v[36:39], a[20:23], a[96:99], v[36:39]
  v_exp_f32 v62, v22
  v_exp_f32 v63, v23
  v_fma_f32 v60, v60, s78, s78
  v_mfma_f32_16x16x32_bf16 v[24:27], a[24:27], a[100:103], v[24:27]
  v_fma_f32 v61, v61, s78, s78
  v_fma_f32 v62, v62, s78, s78
  v_fma_f32 v63, v63, s78, s78
  v_rcp_f32 v60, v60
  v_mfma_f32_16x16x32_bf16 v[28:31], a[28:31], a[100:103], v[28:31]
  v_rcp_f32 v61, v61
  v_rcp_f32 v62, v62
  v_rcp_f32 v63, v63
  v_fma_f32 v60, v60, v20, v68
  v_mfma_f32_16x16x32_bf16 v[32:35], a[32:35], a[100:103], v[32:35]
  v_fma_f32 v61, v61, v21, v69
  v_fma_f32 v62, v62, v22, v70
  v_fma_f32 v63, v63, v23, v71
  v_cvt_pk_bf16_f32 v102, v60, v61
  v_mfma_f32_16x16x32_bf16 v[36:39], a[36:39], a[100:103], v[36:39]
  v_cvt_pk_bf16_f32 v103, v62, v63
  s_nop 1
  v_permlane16_swap_b32 v100, v102
  v_permlane16_swap_b32 v101, v103
  s_movk_i32 s72, 0
  buffer_store_dwordx4 v[100:103], v140, s[40:43], s72 offen offset:64 sc1
  s_waitcnt lgkmcnt(7)
  v_mfma_f32_16x16x32_bf16 v[40:43], a[128:131], a[176:179], v[40:43]
  v_lshlrev_b32 v64, 16, v216
  v_and_b32 v65, s77, v216
  v_mfma_f32_16x16x32_bf16 v[44:47], a[132:135], a[176:179], v[44:47]
  v_lshlrev_b32 v66, 16, v217
  v_and_b32 v67, s77, v217
  v_exp_f32 v56, v24
  v_mfma_f32_16x16x32_bf16 v[48:51], a[136:139], a[176:179], v[48:51]
  v_exp_f32 v57, v25
  v_exp_f32 v58, v26
  v_exp_f32 v59, v27
  v_mfma_f32_16x16x32_bf16 v[52:55], a[140:143], a[176:179], v[52:55]
  v_fma_f32 v56, v56, s78, s78
  v_fma_f32 v57, v57, s78, s78
  v_fma_f32 v58, v58, s78, s78
  s_waitcnt lgkmcnt(6)
  v_mfma_f32_16x16x32_bf16 v[40:43], a[144:147], a[180:183], v[40:43]
  v_fma_f32 v59, v59, s78, s78
  v_rcp_f32 v56, v56
  v_rcp_f32 v57, v57
  v_mfma_f32_16x16x32_bf16 v[44:47], a[148:151], a[180:183], v[44:47]
  v_rcp_f32 v58, v58
  v_rcp_f32 v59, v59
  v_fma_f32 v56, v56, v24, v64
  v_mfma_f32_16x16x32_bf16 v[48:51], a[152:155], a[180:183], v[48:51]
  v_fma_f32 v57, v57, v25, v65
  v_fma_f32 v58, v58, v26, v66
  v_fma_f32 v59, v59, v27, v67
  v_mfma_f32_16x16x32_bf16 v[52:55], a[156:159], a[180:183], v[52:55]
  v_cvt_pk_bf16_f32 v96, v56, v57
  v_cvt_pk_bf16_f32 v97, v58, v59
  s_waitcnt lgkmcnt(5)
  v_mfma_f32_16x16x32_bf16 v[40:43], a[160:163], a[184:187], v[40:43]
  v_lshlrev_b32 v68, 16, v218
  v_and_b32 v69, s77, v218
  v_lshlrev_b32 v70, 16, v219
  v_mfma_f32_16x16x32_bf16 v[44:47], a[164:167], a[184:187], v[44:47]
  v_and_b32 v71, s77, v219
  v_exp_f32 v60, v28
  v_exp_f32 v61, v29
  v_mfma_f32_16x16x32_bf16 v[48:51], a[168:171], a[184:187], v[48:51]
  v_exp_f32 v62, v30
  v_exp_f32 v63, v31
  v_fma_f32 v60, v60, s78, s78
  v_mfma_f32_16x16x32_bf16 v[52:55], a[172:175], a[184:187], v[52:55]
  v_fma_f32 v61, v61, s78, s78
  v_fma_f32 v62, v62, s78, s78
  v_fma_f32 v63, v63, s78, s78
  s_waitcnt lgkmcnt(4)
  v_mfma_f32_16x16x32_bf16 v[40:43], a[216:219], a[188:191], v[40:43]
  v_rcp_f32 v60, v60
  v_rcp_f32 v61, v61
  v_rcp_f32 v62, v62
  v_mfma_f32_16x16x32_bf16 v[44:47], a[220:223], a[188:191], v[44:47]
  v_rcp_f32 v63, v63
  v_fma_f32 v60, v60, v28, v68
  v_fma_f32 v61, v61, v29, v69
  v_mfma_f32_16x16x32_bf16 v[48:51], a[224:227], a[188:191], v[48:51]
  v_fma_f32 v62, v62, v30, v70
  v_fma_f32 v63, v63, v31, v71
  v_cvt_pk_bf16_f32 v98, v60, v61
  v_mfma_f32_16x16x32_bf16 v[52:55], a[228:231], a[188:191], v[52:55]
  v_cvt_pk_bf16_f32 v99, v62, v63
  s_nop 1
  v_permlane16_swap_b32 v96, v98
  v_permlane16_swap_b32 v97, v99
  s_movk_i32 s72, 8192
  buffer_store_dwordx4 v[96:99], v140, s[40:43], s72 offen offset:0 sc1
  s_waitcnt lgkmcnt(3)
  v_mfma_f32_16x16x32_bf16 v[40:43], a[232:235], a[192:195], v[40:43]
  v_lshlrev_b32 v64, 16, v220
  v_and_b32 v65, s77, v220
  v_mfma_f32_16x16x32_bf16 v[44:47], a[236:239], a[192:195], v[44:47]
  v_lshlrev_b32 v66, 16, v221
  v_and_b32 v67, s77, v221
  v_exp_f32 v56, v32
  v_mfma_f32_16x16x32_bf16 v[48:51], a[240:243], a[192:195], v[48:51]
  v_exp_f32 v57, v33
  v_exp_f32 v58, v34
  v_exp_f32 v59, v35
  v_mfma_f32_16x16x32_bf16 v[52:55], a[244:247], a[192:195], v[52:55]
  v_fma_f32 v56, v56, s78, s78
  v_fma_f32 v57, v57, s78, s78
  v_fma_f32 v58, v58, s78, s78
  s_waitcnt lgkmcnt(2)
  v_mfma_f32_16x16x32_bf16 v[40:43], a[248:251], a[196:199], v[40:43]
  v_fma_f32 v59, v59, s78, s78
  v_rcp_f32 v56, v56
  v_rcp_f32 v57, v57
  v_mfma_f32_16x16x32_bf16 v[44:47], a[252:255], a[196:199], v[44:47]
  v_rcp_f32 v58, v58
  v_rcp_f32 v59, v59
  v_fma_f32 v56, v56, v32, v64
  v_mfma_f32_16x16x32_bf16 v[48:51], a[0:3], a[196:199], v[48:51]
  v_fma_f32 v57, v57, v33, v65
  v_fma_f32 v58, v58, v34, v66
  v_fma_f32 v59, v59, v35, v67
  v_mfma_f32_16x16x32_bf16 v[52:55], a[4:7], a[196:199], v[52:55]
  v_cvt_pk_bf16_f32 v100, v56, v57
  v_cvt_pk_bf16_f32 v101, v58, v59
  s_waitcnt lgkmcnt(1)
  v_mfma_f32_16x16x32_bf16 v[40:43], a[8:11], a[200:203], v[40:43]
  v_lshlrev_b32 v68, 16, v222
  v_and_b32 v69, s77, v222
  v_lshlrev_b32 v70, 16, v223
  v_mfma_f32_16x16x32_bf16 v[44:47], a[12:15], a[200:203], v[44:47]
  v_and_b32 v71, s77, v223
  v_exp_f32 v60, v36
  v_exp_f32 v61, v37
  v_mfma_f32_16x16x32_bf16 v[48:51], a[16:19], a[200:203], v[48:51]
  v_exp_f32 v62, v38
  v_exp_f32 v63, v39
  v_fma_f32 v60, v60, s78, s78
  v_mfma_f32_16x16x32_bf16 v[52:55], a[20:23], a[200:203], v[52:55]
  v_fma_f32 v61, v61, s78, s78
  v_fma_f32 v62, v62, s78, s78
  v_fma_f32 v63, v63, s78, s78
  s_waitcnt lgkmcnt(0)
  v_mfma_f32_16x16x32_bf16 v[40:43], a[24:27], a[204:207], v[40:43]
  v_rcp_f32 v60, v60
  v_rcp_f32 v61, v61
  v_rcp_f32 v62, v62
  v_mfma_f32_16x16x32_bf16 v[44:47], a[28:31], a[204:207], v[44:47]
  v_rcp_f32 v63, v63
  v_fma_f32 v60, v60, v36, v68
  v_fma_f32 v61, v61, v37, v69
  v_mfma_f32_16x16x32_bf16 v[48:51], a[32:35], a[204:207], v[48:51]
  v_fma_f32 v62, v62, v38, v70
  v_fma_f32 v63, v63, v39, v71
  v_cvt_pk_bf16_f32 v102, v60, v61
  v_mfma_f32_16x16x32_bf16 v[52:55], a[36:39], a[204:207], v[52:55]
  v_cvt_pk_bf16_f32 v103, v62, v63
  s_nop 1
  v_permlane16_swap_b32 v100, v102
  v_permlane16_swap_b32 v101, v103
  s_movk_i32 s72, 8192
  buffer_store_dwordx4 v[100:103], v140, s[40:43], s72 offen offset:64 sc1
  s_nop 7
  v_lshlrev_b32 v64, 16, v224
  v_and_b32 v65, s77, v224
  v_lshlrev_b32 v66, 16, v225
  v_and_b32 v67, s77, v225
  v_exp_f32 v56, v40
  v_exp_f32 v57, v41
  v_exp_f32 v58, v42
  v_exp_f32 v59, v43
  v_pk_fma_f32 v[56:57], v[56:57], s[78:79], s[78:79]
  v_pk_fma_f32 v[58:59], v[58:59], s[78:79], s[78:79]
  v_rcp_f32 v56, v56
  v_rcp_f32 v57, v57
  v_rcp_f32 v58, v58
  v_rcp_f32 v59, v59
  v_pk_fma_f32 v[56:57], v[56:57], v[40:41], v[64:65]
  v_pk_fma_f32 v[58:59], v[58:59], v[42:43], v[66:67]
  v_cvt_pk_bf16_f32 v96, v56, v57
  v_cvt_pk_bf16_f32 v97, v58, v59
  v_lshlrev_b32 v68, 16, v226
  v_and_b32 v69, s77, v226
  v_lshlrev_b32 v70, 16, v227
  v_and_b32 v71, s77, v227
  v_exp_f32 v60, v44
  v_exp_f32 v61, v45
  v_exp_f32 v62, v46
  v_exp_f32 v63, v47
  v_pk_fma_f32 v[60:61], v[60:61], s[78:79], s[78:79]
  v_pk_fma_f32 v[62:63], v[62:63], s[78:79], s[78:79]
  v_rcp_f32 v60, v60
  v_rcp_f32 v61, v61
  v_rcp_f32 v62, v62
  v_rcp_f32 v63, v63
  v_pk_fma_f32 v[60:61], v[60:61], v[44:45], v[68:69]
  v_pk_fma_f32 v[62:63], v[62:63], v[46:47], v[70:71]
  v_cvt_pk_bf16_f32 v98, v60, v61
  v_cvt_pk_bf16_f32 v99, v62, v63
  s_nop 1
  v_permlane16_swap_b32 v96, v98
  v_permlane16_swap_b32 v97, v99
  s_movk_i32 s72, 16384
  buffer_store_dwordx4 v[96:99], v140, s[40:43], s72 offen offset:0 sc1
  v_lshlrev_b32 v64, 16, v228
  v_and_b32 v65, s77, v228
  v_lshlrev_b32 v66, 16, v229
  v_and_b32 v67, s77, v229
  v_exp_f32 v56, v48
  v_exp_f32 v57, v49
  v_exp_f32 v58, v50
  v_exp_f32 v59, v51
  v_pk_fma_f32 v[56:57], v[56:57], s[78:79], s[78:79]
  v_pk_fma_f32 v[58:59], v[58:59], s[78:79], s[78:79]
  v_rcp_f32 v56, v56
  v_rcp_f32 v57, v57
  v_rcp_f32 v58, v58
  v_rcp_f32 v59, v59
  v_pk_fma_f32 v[56:57], v[56:57], v[48:49], v[64:65]
  v_pk_fma_f32 v[58:59], v[58:59], v[50:51], v[66:67]
  v_cvt_pk_bf16_f32 v100, v56, v57
  v_cvt_pk_bf16_f32 v101, v58, v59
  v_lshlrev_b32 v68, 16, v230
  v_and_b32 v69, s77, v230
  v_lshlrev_b32 v70, 16, v231
  v_and_b32 v71, s77, v231
  v_exp_f32 v60, v52
  v_exp_f32 v61, v53
  v_exp_f32 v62, v54
  v_exp_f32 v63, v55
  v_pk_fma_f32 v[60:61], v[60:61], s[78:79], s[78:79]
  v_pk_fma_f32 v[62:63], v[62:63], s[78:79], s[78:79]
  v_rcp_f32 v60, v60
  v_rcp_f32 v61, v61
  v_rcp_f32 v62, v62
  v_rcp_f32 v63, v63
  v_pk_fma_f32 v[60:61], v[60:61], v[52:53], v[68:69]
  v_pk_fma_f32 v[62:63], v[62:63], v[54:55], v[70:71]
  v_cvt_pk_bf16_f32 v102, v60, v61
  v_cvt_pk_bf16_f32 v103, v62, v63
  s_nop 1
  v_permlane16_swap_b32 v100, v102
  v_permlane16_swap_b32 v101, v103
  s_movk_i32 s72, 16384
  buffer_store_dwordx4 v[100:103], v140, s[40:43], s72 offen offset:64 sc1
  s_endpgm
L_slow_start:
  v_mov_b32 v160, 0
  v_mov_b32 v161, 0
  v_mov_b32 v162, 0
  v_mov_b32 v163, 0
  v_mov_b32 v164, 0
  v_mov_b32 v165, 0
  v_mov_b32 v166, 0
  v_mov_b32 v167, 0
  v_mov_b32 v168, 0
  v_mov_b32 v169, 0
  v_mov_b32 v170, 0
  v_mov_b32 v171, 0
  v_mov_b32 v172, 0
  v_mov_b32 v173, 0
  v_mov_b32 v174, 0
  v_mov_b32 v175, 0
  v_mov_b32 v176, 0
  v_mov_b32 v177, 0
  v_mov_b32 v178, 0
  v_mov_b32 v179, 0
  v_mov_b32 v180, 0
  v_mov_b32 v181, 0
  v_mov_b32 v182, 0
  v_mov_b32 v183, 0
  v_mov_b32 v184, 0
  v_mov_b32 v185, 0
  v_mov_b32 v186, 0
  v_mov_b32 v187, 0
  v_mov_b32 v188, 0
  v_mov_b32 v189, 0
  v_mov_b32 v190, 0
  v_mov_b32 v191, 0
  v_mov_b32 v192, 0
  v_mov_b32 v193, 0
  v_mov_b32 v194, 0
  v_mov_b32 v195, 0
  v_mov_b32 v196, 0
  v_mov_b32 v197, 0
  v_mov_b32 v198, 0
  v_mov_b32 v199, 0
  v_mov_b32 v200, 0
  v_mov_b32 v201, 0
  v_mov_b32 v202, 0
  v_mov_b32 v203, 0
  v_mov_b32 v204, 0
  v_mov_b32 v205, 0
  v_mov_b32 v206, 0
  v_mov_b32 v207, 0
  v_mov_b32 v208, 0
  v_mov_b32 v209, 0
  v_mov_b32 v210, 0
  v_mov_b32 v211, 0
  v_mov_b32 v212, 0
  v_mov_b32 v213, 0
  v_mov_b32 v214, 0
  v_mov_b32 v215, 0
  v_mov_b32 v216, 0
  v_mov_b32 v217, 0
  v_mov_b32 v218, 0
  v_mov_b32 v219, 0
  v_mov_b32 v220, 0
  v_mov_b32 v221, 0
  v_mov_b32 v222, 0
  v_mov_b32 v223, 0
  v_mov_b32 v224, 0
  v_mov_b32 v225, 0
  v_mov_b32 v226, 0
  v_mov_b32 v227, 0
  v_mov_b32 v228, 0
  v_mov_b32 v229, 0
  v_mov_b32 v230, 0
  v_mov_b32 v231, 0
  v_mov_b32 v232, 0
  v_mov_b32 v233, 0
  v_mov_b32 v234, 0
  v_mov_b32 v235, 0
  v_mov_b32 v236, 0
  v_mov_b32 v237, 0
  v_mov_b32 v238, 0
  v_mov_b32 v239, 0
  s_mov_b32 s74, 0
L_slow_pass:
  s_sub_u32 s75, s57, s74
  s_min_u32 s75, s75, 512
  s_waitcnt vmcnt(0) lgkmcnt(0)
  s_barrier
  v_mov_b32 v40, 0x7f000000
  v_mov_b32 v41, v40
  v_mov_b32 v42, v40
  v_mov_b32 v43, v40
  v_lshlrev_b32 v44, 4, v114
  v_add_u32 v44, 154624, v44
  ds_write_b128 v44, v[40:43]
  v_cmp_gt_u32 s[68:69], 16, v114
  v_mov_b32 v45, 0
  v_lshlrev_b32 v46, 2, v114
  v_add_u32 v46, 158976, v46
  s_mov_b64 exec, s[68:69]
  ds_write_b128 v44, v[40:43] offset:4096
  s_mov_b64 exec, -1
  v_cmp_gt_u32 s[68:69], 8, v114
  s_nop 3
  s_mov_b64 exec, s[68:69]
  ds_write_b32 v46, v45
  s_mov_b64 exec, -1
  v_mov_b32 v40, 0
  v_mov_b32 v41, 0
  v_mov_b32 v42, 0
  v_mov_b32 v43, 0
  v_lshlrev_b32 v44, 4, v114
  v_add_u32 v44, 65536, v44
  v_add_u32 v45, 0xc000, v44
  ds_write_b128 v44, v[40:43] offset:0
  ds_write_b128 v44, v[40:43] offset:4096
  ds_write_b128 v44, v[40:43] offset:8192
  ds_write_b128 v44, v[40:43] offset:12288
  ds_write_b128 v44, v[40:43] offset:16384
  ds_write_b128 v44, v[40:43] offset:20480
  ds_write_b128 v44, v[40:43] offset:24576
  ds_write_b128 v44, v[40:43] offset:28672
  ds_write_b128 v44, v[40:43] offset:32768
  ds_write_b128 v44, v[40:43] offset:36864
  ds_write_b128 v44, v[40:43] offset:40960
  ds_write_b128 v44, v[40:43] offset:45056
  ds_write_b128 v45, v[40:43] offset:0
  ds_write_b128 v45, v[40:43] offset:4096
  ds_write_b128 v45, v[40:43] offset:8192
  ds_write_b128 v45, v[40:43] offset:12288
  ds_write_b128 v45, v[40:43] offset:16384
  ds_write_b128 v45, v[40:43] offset:20480
  ds_write_b128 v45, v[40:43] offset:24576
  ds_write_b128 v45, v[40:43] offset:28672
  ds_write_b128 v45, v[40:43] offset:32768
  v_cmp_gt_u32 vcc, 192, v114
  s_nop 3
  s_mov_b64 s[68:69], vcc
  s_mov_b64 exec, s[68:69]
  ds_write_b128 v45, v[40:43] offset:36864
  s_mov_b64 exec, -1
  v_subrev_u32 v40, s74, v157
  v_sub_u32 v41, 0, v40
  v_max_i32 v41, 0, v41
  v_sub_u32 v42, 512, v40
  v_min_i32 v42, v42, v156
  v_add_u32 v41, s12, v41
  v_add_u32 v43, v41, v158
  v_add_u32 v44, v41, v40
  v_lshlrev_b32 v44, 2, v44
L_desc_3:
  v_cmp_lt_i32 vcc, v41, v42
  v_add_u32 v41, 4, v41
  s_and_b64 exec, exec, vcc
  s_cbranch_scc0 L_desc_done_4
  ds_write_b32 v44, v43 offset:0
  v_add_u32 v43, 4, v43
  v_add_u32 v44, 16, v44
  s_branch L_desc_3
L_desc_done_4:
  s_mov_b64 exec, -1
  s_waitcnt lgkmcnt(0)
  s_barrier
  v_lshlrev_b32 v40, 2, v114
  ds_read_b32 v41, v40 offset:0
  ds_read_b32 v42, v40 offset:1024
  ds_read_b32 v43, v40 offset:2048
  s_sub_i32 s70, s75, 0
  v_cmp_gt_i32 s[62:63], s70, v114
  s_sub_i32 s70, s75, 256
  v_cmp_gt_i32 s[64:65], s70, v114
  s_sub_i32 s70, s75, 512
  v_cmp_gt_i32 s[66:67], s70, v114
  v_mov_b32 v44, 0x0fffffff
  s_waitcnt lgkmcnt(0)
  v_cndmask_b32 v41, v44, v41, s[62:63]
  v_lshlrev_b32 v45, 2, v41
  v_lshlrev_b32 v46, 3, v41
  buffer_load_dword v0, v45, s[20:23], 0 offen
  buffer_load_dwordx2 v[2:3], v46, s[24:27], 0 offen
  v_cndmask_b32 v42, v44, v42, s[64:65]
  v_lshlrev_b32 v45, 2, v42
  v_lshlrev_b32 v46, 3, v42
  buffer_load_dword v10, v45, s[20:23], 0 offen
  buffer_load_dwordx2 v[12:13], v46, s[24:27], 0 offen
  v_cndmask_b32 v43, v44, v43, s[66:67]
  v_lshlrev_b32 v45, 2, v43
  v_lshlrev_b32 v46, 3, v43
  buffer_load_dword v20, v45, s[20:23], 0 offen
  buffer_load_dwordx2 v[22:23], v46, s[24:27], 0 offen
  v_mov_b32 v43, 1
  v_mov_b32 v44, 158976
  s_lshl_b32 s71, s13, 3
  s_waitcnt vmcnt(4)
  v_bfe_u32 v40, v0, 3, 3
  v_lshl_add_u32 v40, v40, 2, v44
  v_lshrrev_b32 v41, 9, v0
  v_lshlrev_b32 v41, 3, v41
  v_and_b32 v42, 63, v0
  v_lshlrev_b32 v42, 3, v42
  s_mov_b64 exec, s[62:63]
  ds_add_rtn_u32 v1, v40, v43
  s_mov_b64 exec, -1
  buffer_load_dwordx2 v[6:7], v41, s[28:31], 0 offen
  buffer_load_dwordx2 v[8:9], v42, s[28:31], s71 offen
  s_waitcnt vmcnt(4)
  v_bfe_u32 v40, v10, 3, 3
  v_lshl_add_u32 v40, v40, 2, v44
  v_lshrrev_b32 v41, 9, v10
  v_lshlrev_b32 v41, 3, v41
  v_and_b32 v42, 63, v10
  v_lshlrev_b32 v42, 3, v42
  s_mov_b64 exec, s[64:65]
  ds_add_rtn_u32 v11, v40, v43
  s_mov_b64 exec, -1
  buffer_load_dwordx2 v[16:17], v41, s[28:31], 0 offen
  buffer_load_dwordx2 v[18:19], v42, s[28:31], s71 offen
  s_waitcnt vmcnt(4)
  v_bfe_u32 v40, v20, 3, 3
  v_lshl_add_u32 v40, v40, 2, v44
  v_lshrrev_b32 v41, 9, v20
  v_lshlrev_b32 v41, 3, v41
  v_and_b32 v42, 63, v20
  v_lshlrev_b32 v42, 3, v42
  s_mov_b64 exec, s[66:67]
  ds_add_rtn_u32 v21, v40, v43
  s_mov_b64 exec, -1
  buffer_load_dwordx2 v[26:27], v41, s[28:31], 0 offen
  buffer_load_dwordx2 v[28:29], v42, s[28:31], s71 offen
  s_waitcnt lgkmcnt(0)
  s_barrier
  v_min_u32 v40, 7, v115
  v_lshlrev_b32 v40, 2, v40
  v_add_u32 v40, 158976, v40
  ds_read_b32 v41, v40
  v_cmp_gt_u32 vcc, 5, v115
  s_waitcnt lgkmcnt(0)
  v_add_u32 v41, 31, v41
  v_lshrrev_b32 v41, 5, v41
  v_max_u32 v41, 1, v41
  v_cndmask_b32 v41, 0, v41, vcc
  v_mov_b32 v42, v41
  s_nop 1
  v_add_u32_dpp v42, v42, v42 row_shr:1 row_mask:0xf bank_mask:0xf bound_ctrl:0
  s_nop 1
  v_add_u32_dpp v42, v42, v42 row_shr:2 row_mask:0xf bank_mask:0xf bound_ctrl:0
  s_nop 1
  v_add_u32_dpp v42, v42, v42 row_shr:4 row_mask:0xf bank_mask:0xf bound_ctrl:0
  s_nop 1
  v_sub_u32 v43, v42, v41
  v_lshlrev_b32 v43, 5, v43
  s_mov_b32 s53, 0
  v_readlane_b32 s70, v42, 0
  s_nop 0
  s_lshl_b32 s70, 1, s70
  s_or_b32 s53, s53, s70
  v_readlane_b32 s70, v42, 1
  s_nop 0
  s_lshl_b32 s70, 1, s70
  s_or_b32 s53, s53, s70
  v_readlane_b32 s70, v42, 2
  s_nop 0
  s_lshl_b32 s70, 1, s70
  s_or_b32 s53, s53, s70
  v_readlane_b32 s70, v42, 3
  s_nop 0
  s_lshl_b32 s70, 1, s70
  s_or_b32 s53, s53, s70
  v_readlane_b32 s70, v42, 4
  s_nop 0
  s_max_u32 s70, s70, 6
  s_lshl_b32 s70, 1, s70
  s_or_b32 s53, s53, s70
  v_bfe_u32 v44, v0, 3, 3
  v_lshlrev_b32 v44, 2, v44
  ds_bpermute_b32 v48, v44, v43
  v_bfe_u32 v45, v10, 3, 3
  v_lshlrev_b32 v45, 2, v45
  ds_bpermute_b32 v49, v45, v43
  v_bfe_u32 v46, v20, 3, 3
  v_lshlrev_b32 v46, 2, v46
  ds_bpermute_b32 v50, v46, v43
  s_waitcnt lgkmcnt(2)
  v_add_u32 v1, v1, v48
  v_lshrrev_b32 v52, 5, v1
  v_and_b32 v53, 7, v1
  v_lshlrev_b32 v53, 4, v53
  v_lshl_add_u32 v52, v52, 7, v53
  v_bfe_u32 v53, v1, 3, 2
  v_lshl_add_u32 v52, v53, 2, v52
  v_add_u32 v52, 154624, v52
  v_and_b32 v53, 0xfffffe00, v0
  s_mov_b64 exec, s[62:63]
  ds_write_b32 v52, v53
  s_mov_b64 exec, -1
  s_waitcnt lgkmcnt(2)
  v_add_u32 v11, v11, v49
  v_lshrrev_b32 v52, 5, v11
  v_and_b32 v53, 7, v11
  v_lshlrev_b32 v53, 4, v53
  v_lshl_add_u32 v52, v52, 7, v53
  v_bfe_u32 v53, v11, 3, 2
  v_lshl_add_u32 v52, v53, 2, v52
  v_add_u32 v52, 154624, v52
  v_and_b32 v53, 0xfffffe00, v10
  s_mov_b64 exec, s[64:65]
  ds_write_b32 v52, v53
  s_mov_b64 exec, -1
  s_waitcnt lgkmcnt(2)
  v_add_u32 v21, v21, v50
  v_lshrrev_b32 v52, 5, v21
  v_and_b32 v53, 7, v21
  v_lshlrev_b32 v53, 4, v53
  v_lshl_add_u32 v52, v52, 7, v53
  v_bfe_u32 v53, v21, 3, 2
  v_lshl_add_u32 v52, v53, 2, v52
  v_add_u32 v52, 154624, v52
  v_and_b32 v53, 0xfffffe00, v20
  s_mov_b64 exec, s[66:67]
  ds_write_b32 v52, v53
  s_mov_b64 exec, -1
  s_waitcnt lgkmcnt(0)
  s_barrier
  v_lshrrev_b32 v113, 3, v115
  v_lshlrev_b32 v113, 4, v113
  v_add_u32 v113, 154624, v113
  v_add_u32 v112, 65536, v159
  ds_read_b128 v[96:99], v113 offset:0
  s_waitcnt lgkmcnt(0)
  v_add_u32 v100, v96, v104
  v_add_u32 v101, v97, v105
  v_add_u32 v102, v98, v106
  v_add_u32 v103, v99, v107
  s_mov_b32 m0, s48
  s_nop 0
  buffer_load_dwordx4 v100, s[16:19], s52 offen offset:0 lds
  buffer_load_dwordx4 v101, s[16:19], s52 offen offset:1024 lds
  buffer_load_dwordx4 v102, s[16:19], s52 offen offset:2048 lds
  buffer_load_dwordx4 v103, s[16:19], s52 offen offset:3072 lds
  ds_read_b128 v[96:99], v113 offset:128
  s_waitcnt lgkmcnt(0)
  v_add_u32 v100, v96, v104
  v_add_u32 v101, v97, v105
  v_add_u32 v102, v98, v106
  v_add_u32 v103, v99, v107
  s_mov_b32 m0, s49
  s_nop 0
  buffer_load_dwordx4 v100, s[16:19], s52 offen offset:0 lds
  buffer_load_dwordx4 v101, s[16:19], s52 offen offset:1024 lds
  buffer_load_dwordx4 v102, s[16:19], s52 offen offset:2048 lds
  buffer_load_dwordx4 v103, s[16:19], s52 offen offset:3072 lds
  ds_read_b128 v[96:99], v113 offset:256
  s_waitcnt lgkmcnt(0)
  v_add_u32 v100, v96, v104
  v_add_u32 v101, v97, v105
  v_add_u32 v102, v98, v106
  v_add_u32 v103, v99, v107
  s_mov_b32 m0, s50
  s_nop 0
  buffer_load_dwordx4 v100, s[16:19], s52 offen offset:0 lds
  buffer_load_dwordx4 v101, s[16:19], s52 offen offset:1024 lds
  buffer_load_dwordx4 v102, s[16:19], s52 offen offset:2048 lds
  buffer_load_dwordx4 v103, s[16:19], s52 offen offset:3072 lds
  ds_read_b128 v[96:99], v113 offset:384
  s_waitcnt lgkmcnt(0)
  v_add_u32 v100, v96, v104
  v_add_u32 v101, v97, v105
  v_add_u32 v102, v98, v106
  v_add_u32 v103, v99, v107
  s_mov_b32 m0, s51
  s_nop 0
  buffer_load_dwordx4 v100, s[16:19], s52 offen offset:0 lds
  buffer_load_dwordx4 v101, s[16:19], s52 offen offset:1024 lds
  buffer_load_dwordx4 v102, s[16:19], s52 offen offset:2048 lds
  buffer_load_dwordx4 v103, s[16:19], s52 offen offset:3072 lds
  v_mov_b32 v55, 0x3f80
  s_waitcnt vmcnt(20)
  v_lshlrev_b32 v40, 16, v6
  v_and_b32 v41, s77, v6
  v_lshlrev_b32 v42, 16, v7
  v_lshlrev_b32 v43, 16, v8
  v_and_b32 v44, s77, v8
  v_lshlrev_b32 v45, 16, v9
  v_sub_f32 v40, v43, v40
  v_sub_f32 v41, v44, v41
  v_sub_f32 v42, v45, v42
  v_cvt_pk_bf16_f32 v6, v40, v41
  v_cvt_pk_bf16_f32 v7, v42, v42
  v_lshrrev_b32 v46, 5, v1
  v_mul_u32_u24 v46, 3072, v46
  v_add_u32 v46, 65536, v46
  v_lshlrev_b32 v40, 16, v6
  v_and_b32 v41, s77, v6
  v_lshlrev_b32 v42, 16, v7
  v_mul_f32 v42, v42, v42
  v_fmac_f32 v42, v41, v41
  v_fmac_f32 v42, v40, v40
  v_and_b32 v47, 31, v1
  v_and_b32 v48, 7, v0
  v_cvt_pk_bf16_f32 v4, v42, v42
  v_mov_b32 v5, v2
  v_lshl_add_u32 v49, v47, 4, v46
  v_lshl_add_u32 v50, v48, 1, v49
  v_bfe_u32 v51, v47, 4, 1
  v_lshl_add_u32 v52, v51, 10, v46
  v_bfe_u32 v51, v47, 2, 1
  v_lshl_add_u32 v52, v51, 9, v52
  v_and_b32 v51, 8, v47
  v_add_u32 v52, v51, v52
  v_and_b32 v51, 3, v47
  v_lshl_add_u32 v52, v51, 1, v52
  v_lshl_add_u32 v52, v48, 6, v52
  s_mov_b64 exec, s[62:63]
  ds_write_b128 v49, v[2:5]
  ds_write_b16 v50, v55 offset:512
  ds_write_b16 v52, v55 offset:1024
  ds_write_b16 v52, v6 offset:1040
  ds_write_b16_d16_hi v52, v6 offset:1056
  ds_write_b16 v52, v7 offset:1072
  s_mov_b64 exec, -1
  s_waitcnt vmcnt(18)
  v_lshlrev_b32 v40, 16, v16
  v_and_b32 v41, s77, v16
  v_lshlrev_b32 v42, 16, v17
  v_lshlrev_b32 v43, 16, v18
  v_and_b32 v44, s77, v18
  v_lshlrev_b32 v45, 16, v19
  v_sub_f32 v40, v43, v40
  v_sub_f32 v41, v44, v41
  v_sub_f32 v42, v45, v42
  v_cvt_pk_bf16_f32 v16, v40, v41
  v_cvt_pk_bf16_f32 v17, v42, v42
  v_lshrrev_b32 v46, 5, v11
  v_mul_u32_u24 v46, 3072, v46
  v_add_u32 v46, 65536, v46
  v_lshlrev_b32 v40, 16, v16
  v_and_b32 v41, s77, v16
  v_lshlrev_b32 v42, 16, v17
  v_mul_f32 v42, v42, v42
  v_fmac_f32 v42, v41, v41
  v_fmac_f32 v42, v40, v40
  v_and_b32 v47, 31, v11
  v_and_b32 v48, 7, v10
  v_cvt_pk_bf16_f32 v14, v42, v42
  v_mov_b32 v15, v12
  v_lshl_add_u32 v49, v47, 4, v46
  v_lshl_add_u32 v50, v48, 1, v49
  v_bfe_u32 v51, v47, 4, 1
  v_lshl_add_u32 v52, v51, 10, v46
  v_bfe_u32 v51, v47, 2, 1
  v_lshl_add_u32 v52, v51, 9, v52
  v_and_b32 v51, 8, v47
  v_add_u32 v52, v51, v52
  v_and_b32 v51, 3, v47
  v_lshl_add_u32 v52, v51, 1, v52
  v_lshl_add_u32 v52, v48, 6, v52
  s_mov_b64 exec, s[64:65]
  ds_write_b128 v49, v[12:15]
  ds_write_b16 v50, v55 offset:512
  ds_write_b16 v52, v55 offset:1024
  ds_write_b16 v52, v16 offset:1040
  ds_write_b16_d16_hi v52, v16 offset:1056
  ds_write_b16 v52, v17 offset:1072
  s_mov_b64 exec, -1
  s_waitcnt vmcnt(16)
  v_lshlrev_b32 v40, 16, v26
  v_and_b32 v41, s77, v26
  v_lshlrev_b32 v42, 16, v27
  v_lshlrev_b32 v43, 16, v28
  v_and_b32 v44, s77, v28
  v_lshlrev_b32 v45, 16, v29
  v_sub_f32 v40, v43, v40
  v_sub_f32 v41, v44, v41
  v_sub_f32 v42, v45, v42
  v_cvt_pk_bf16_f32 v26, v40, v41
  v_cvt_pk_bf16_f32 v27, v42, v42
  v_lshrrev_b32 v46, 5, v21
  v_mul_u32_u24 v46, 3072, v46
  v_add_u32 v46, 65536, v46
  v_lshlrev_b32 v40, 16, v26
  v_and_b32 v41, s77, v26
  v_lshlrev_b32 v42, 16, v27
  v_mul_f32 v42, v42, v42
  v_fmac_f32 v42, v41, v41
  v_fmac_f32 v42, v40, v40
  v_and_b32 v47, 31, v21
  v_and_b32 v48, 7, v20
  v_cvt_pk_bf16_f32 v24, v42, v42
  v_mov_b32 v25, v22
  v_lshl_add_u32 v49, v47, 4, v46
  v_lshl_add_u32 v50, v48, 1, v49
  v_bfe_u32 v51, v47, 4, 1
  v_lshl_add_u32 v52, v51, 10, v46
  v_bfe_u32 v51, v47, 2, 1
  v_lshl_add_u32 v52, v51, 9, v52
  v_and_b32 v51, 8, v47
  v_add_u32 v52, v51, v52
  v_and_b32 v51, 3, v47
  v_lshl_add_u32 v52, v51, 1, v52
  v_lshl_add_u32 v52, v48, 6, v52
  s_mov_b64 exec, s[66:67]
  ds_write_b128 v49, v[22:25]
  ds_write_b16 v50, v55 offset:512
  ds_write_b16 v52, v55 offset:1024
  ds_write_b16 v52, v26 offset:1040
  ds_write_b16_d16_hi v52, v26 offset:1056
  ds_write_b16 v52, v27 offset:1072
  s_mov_b64 exec, -1
  s_waitcnt lgkmcnt(0)
  s_barrier
  v_mov_b32 v48, 0
  v_accvgpr_write_b32 a196, 0
  v_mov_b32 v49, 0
  v_accvgpr_write_b32 a197, 0
  v_mov_b32 v50, 0
  v_accvgpr_write_b32 a198, 0
  v_mov_b32 v51, 0
  v_accvgpr_write_b32 a199, 0
  v_mov_b32 v52, 0
  v_accvgpr_write_b32 a200, 0
  v_mov_b32 v53, 0
  v_accvgpr_write_b32 a201, 0
  v_mov_b32 v54, 0
  v_accvgpr_write_b32 a202, 0
  v_mov_b32 v55, 0
  v_accvgpr_write_b32 a203, 0
  v_mov_b32 v56, v116
  v_mov_b32 v57, v117
  v_mov_b32 v58, v118
  v_mov_b32 v59, v119
  v_mov_b32 v60, v120
  v_mov_b32 v61, v121
  v_mov_b32 v62, v122
  v_mov_b32 v63, v123
  s_mov_b32 s54, 0
  s_mov_b32 s55, 0
  s_set_gpr_idx_on s55, gpr_idx(SRC1)
  v_lshlrev_b32 v64, 16, v160
  v_and_b32 v65, s77, v160
  v_lshlrev_b32 v66, 16, v161
  v_and_b32 v67, s77, v161
  v_lshlrev_b32 v68, 16, v162
  v_and_b32 v69, s77, v162
  v_lshlrev_b32 v70, 16, v163
  v_and_b32 v71, s77, v163
  v_lshlrev_b32 v72, 16, v164
  v_and_b32 v73, s77, v164
  v_lshlrev_b32 v74, 16, v165
  v_and_b32 v75, s77, v165
  v_lshlrev_b32 v76, 16, v166
  v_and_b32 v77, s77, v166
  v_lshlrev_b32 v78, 16, v167
  v_and_b32 v79, s77, v167
  s_set_gpr_idx_off
  s_set_gpr_idx_on s55, gpr_idx(SRC1)
  v_lshlrev_b32 v80, 16, v168
  v_and_b32 v81, s77, v168
  v_lshlrev_b32 v82, 16, v169
  v_and_b32 v83, s77, v169
  v_lshlrev_b32 v84, 16, v170
  v_and_b32 v85, s77, v170
  v_lshlrev_b32 v86, 16, v171
  v_and_b32 v87, s77, v171
  v_lshlrev_b32 v88, 16, v172
  v_and_b32 v89, s77, v172
  v_lshlrev_b32 v90, 16, v173
  v_and_b32 v91, s77, v173
  v_lshlrev_b32 v92, 16, v174
  v_and_b32 v93, s77, v174
  v_lshlrev_b32 v94, 16, v175
  v_and_b32 v95, s77, v175
  s_set_gpr_idx_off
  s_branch L_fill
L_slow_next:
  s_add_u32 s74, s74, 512
  s_cmp_lt_u32 s74, s57
  s_cbranch_scc1 L_slow_pass
  s_branch L_tail
L_handler:
  s_bitcmp1_b32 s53, 0
  s_cbranch_scc0 L_h_y
  s_set_gpr_idx_on s55, gpr_idx(DST)
  v_cvt_pk_bf16_f32 v160, v64, v65
  v_cvt_pk_bf16_f32 v161, v66, v67
  v_cvt_pk_bf16_f32 v162, v68, v69
  v_cvt_pk_bf16_f32 v163, v70, v71
  v_cvt_pk_bf16_f32 v164, v72, v73
  v_cvt_pk_bf16_f32 v165, v74, v75
  v_cvt_pk_bf16_f32 v166, v76, v77
  v_cvt_pk_bf16_f32 v167, v78, v79
  v_cvt_pk_bf16_f32 v168, v80, v81
  v_cvt_pk_bf16_f32 v169, v82, v83
  v_cvt_pk_bf16_f32 v170, v84, v85
  v_cvt_pk_bf16_f32 v171, v86, v87
  v_cvt_pk_bf16_f32 v172, v88, v89
  v_cvt_pk_bf16_f32 v173, v90, v91
  v_cvt_pk_bf16_f32 v174, v92, v93
  v_cvt_pk_bf16_f32 v175, v94, v95
  s_set_gpr_idx_off
  s_add_u32 s55, s55, 16
  s_cmp_lg_u32 s76, 0
  s_cbranch_scc1 L_h_slow
  v_mfma_f32_32x32x16_bf16 v[80:95], a[212:215], a[212:215], 0
  v_mfma_f32_32x32x16_bf16 v[64:79], a[212:215], a[212:215], 0
L_h_y:
  s_bitcmp1_b32 s53, 1
  s_cbranch_scc0 L_h_ret
  s_add_u32 s54, s54, 8
  s_set_gpr_idx_on s54, gpr_idx(SRC0)
  v_mov_b32 v56, v116
  v_mov_b32 v57, v117
  v_mov_b32 v58, v118
  v_mov_b32 v59, v119
  v_mov_b32 v60, v120
  v_mov_b32 v61, v121
  v_mov_b32 v62, v122
  v_mov_b32 v63, v123
  s_set_gpr_idx_off
L_h_ret:
  s_cmp_ge_u32 s14, 10
  s_cbranch_scc1 L_tree_5
  s_cmp_ge_u32 s14, 2
  s_cbranch_scc1 L_tree_6
  s_cmp_eq_u32 s14, 0
  s_cbranch_scc1 L_ret0
  s_branch L_ret1
L_tree_6:
  s_cmp_eq_u32 s14, 2
  s_cbranch_scc1 L_ret2
  s_branch L_ret3
L_tree_5:
  s_cmp_ge_u32 s14, 12
  s_cbranch_scc1 L_tree_9
  s_cmp_eq_u32 s14, 10
  s_cbranch_scc1 L_ret10
  s_branch L_ret11
L_tree_9:
  s_cmp_ge_u32 s14, 13
  s_cbranch_scc1 L_tree_11
  s_branch L_ret12
L_tree_11:
  s_cmp_eq_u32 s14, 13
  s_cbranch_scc1 L_ret13
  s_branch L_ret14
L_h_slow:
  s_set_gpr_idx_on s55, gpr_idx(SRC1)
  v_lshlrev_b32 v64, 16, v160
  v_and_b32 v65, s77, v160
  v_lshlrev_b32 v66, 16, v161
  v_and_b32 v67, s77, v161
  v_lshlrev_b32 v68, 16, v162
  v_and_b32 v69, s77, v162
  v_lshlrev_b32 v70, 16, v163
  v_and_b32 v71, s77, v163
  v_lshlrev_b32 v72, 16, v164
  v_and_b32 v73, s77, v164
  v_lshlrev_b32 v74, 16, v165
  v_and_b32 v75, s77, v165
  v_lshlrev_b32 v76, 16, v166
  v_and_b32 v77, s77, v166
  v_lshlrev_b32 v78, 16, v167
  v_and_b32 v79, s77, v167
  s_set_gpr_idx_off
  s_set_gpr_idx_on s55, gpr_idx(SRC1)
  v_lshlrev_b32 v80, 16, v168
  v_and_b32 v81, s77, v168
  v_lshlrev_b32 v82, 16, v169
  v_and_b32 v83, s77, v169
  v_lshlrev_b32 v84, 16, v170
  v_and_b32 v85, s77, v170
  v_lshlrev_b32 v86, 16, v171
  v_and_b32 v87, s77, v171
  v_lshlrev_b32 v88, 16, v172
  v_and_b32 v89, s77, v172
  v_lshlrev_b32 v90, 16, v173
  v_and_b32 v91, s77, v173
  v_lshlrev_b32 v92, 16, v174
  v_and_b32 v93, s77, v174
  v_lshlrev_b32 v94, 16, v175
  v_and_b32 v95, s77, v175
  s_set_gpr_idx_off
  s_branch L_h_y
L_main_exit:
  s_endpgm
.section .rodata,"a"
.p2align 6
.amdhsa_kernel egnn_main_kernel
  .amdhsa_next_free_vgpr 512
  .amdhsa_next_free_sgpr 102
  .amdhsa_accum_offset 256
  .amdhsa_group_segment_fixed_size 0
  .amdhsa_kernarg_size 88
  .amdhsa_user_sgpr_count 2
  .amdhsa_user_sgpr_kernarg_segment_ptr 1
  .amdhsa_system_sgpr_workgroup_id_x 1
  .amdhsa_float_denorm_mode_32 3
.end_amdhsa_kernel
.text
```
